```python
import torch

def _softmax(x, axis=-1):
    return torch.softmax(x, dim=axis)
def _gelu(x):
    return torch.nn.functional.gelu(x, approximate="tanh")
def _silu(x):
    return torch.nn.functional.silu(x)
def _sigmoid(x):
    return torch.sigmoid(x)
def _layernorm(x, axis=-1, eps=1e-5):
    m = x.mean(dim=axis, keepdim=True)
    v = x.var(dim=axis, keepdim=True, unbiased=False)
    return (x - m) / torch.sqrt(v + eps)
def _scatter_add(tgt, idx, src, axis=0):
    return tgt.clone().index_add_(axis, idx, src)
def _segment_sum(src, seg, n):
    out = torch.zeros((n,) + src.shape[1:], dtype=src.dtype)
    return out.index_add_(0, seg, src)
def _pad(x, pw):
    flat = tuple(v for pair in reversed(pw) for v in pair)
    return torch.nn.functional.pad(x, flat)

kernel_name = 'standalone__mha_block_cached__near_ridge'

def setup_inputs():

    _w = (lambda a: (lambda t: t.to(torch.bfloat16) if t.is_floating_point() else t)(torch.as_tensor(a)))
    B, Sq, D = 16, 144, 576
    H, Sk, Dh = 32, 512, 128
    return {
        "x": _w((lambda *s: torch.randn(*s, dtype=torch.bfloat16) * 0.8)(B, Sq, D)),
        "k_cache": _w((lambda *s: torch.randn(*s, dtype=torch.bfloat16) * 0.8)(B, H, Sk, Dh)),
        "v_cache": _w((lambda *s: torch.randn(*s, dtype=torch.bfloat16) * 0.05)(B, H, Sk, Dh)),
        "wq": _w((lambda *s: torch.randn(*s, dtype=torch.bfloat16) * 0.8)(D, H * Dh) * (D ** -0.5)),
        "wo": _w((lambda *s: torch.randn(*s, dtype=torch.bfloat16) * 0.05)(H * Dh, D) * ((H * Dh) ** -0.5)),
    }

def reference(x, k_cache, v_cache, wq, wo):
    B, Sq, D = x.shape
    H, Dh = 32, 128
    q = (lambda x, *d: x.permute(*d))((x @ wq).reshape(B, Sq, H, Dh), 0, 2, 1, 3)
    scores = torch.einsum("bhqd,bhkd->bhqk", q, k_cache) * (Dh ** -0.5)
    p = _softmax(scores, axis=-1)
    o = torch.einsum("bhqk,bhkd->bhqd", p, v_cache)
    return (lambda x, *d: x.permute(*d))(o, 0, 2, 1, 3).reshape(B, Sq, H * Dh) @ wo
```

```asm
; @launch grid=(256,1,1) block=(256,1,1) lds=163840
.amdgcn_target "amdgcn-amd-amdhsa--gfx950"
.text
.globl standalone__mha_block_cached__near_ridge_kernel
.p2align 8
.type standalone__mha_block_cached__near_ridge_kernel,@function
standalone__mha_block_cached__near_ridge_kernel:
  s_cmp_ge_u32 s2, 256
  s_cbranch_scc1 K1_END
  s_cmp_ge_u32 s2, 224
  s_cbranch_scc0 K1_NOCPF
  s_getpc_b64 s[40:41]
K1_PC:
  v_lshlrev_b32 v1, 7, v0
  v_cmp_gt_u32 vcc, K1_CODE_END-K1_PC, v1
  s_and_saveexec_b64 s[42:43], vcc
  global_load_dword v67, v1, s[40:41]
  s_mov_b64 exec, s[42:43]
K1_NOCPF:
  s_load_dwordx4 s[4:7], s[0:1], 0
  s_load_dwordx4 s[12:15], s[0:1], 16
  s_load_dwordx2 s[20:21], s[0:1], 56
  s_load_dwordx2 s[24:25], s[0:1], 32
  s_load_dwordx2 s[100:101], s[0:1], 48
  v_lshrrev_b32 v1, 6, v0
  v_and_b32 v0, 63, v0
  s_nop 0
  v_readfirstlane_b32 s3, v1
  s_and_b32 s40, s2, 7
  s_lshr_b32 s41, s2, 3
  s_lshr_b32 s42, s40, 1
  s_lshl_b32 s42, s42, 2
  s_and_b32 s43, s41, 3
  s_add_u32 s28, s42, s43
  s_and_b32 s42, s40, 1
  s_lshl_b32 s42, s42, 3
  s_lshr_b32 s43, s41, 2
  s_add_u32 s29, s42, s43
  s_lshl_b32 s38, s3, 12
  s_mov_b32 s39, 0x3e0293ee
  s_lshl_b32 s56, s3, 11
  s_mul_i32 s57, s3, 2304
  v_and_b32 v1, 15, v0
  v_lshrrev_b32 v2, 4, v0
  v_and_b32 v3, 31, v0
  v_lshrrev_b32 v4, 5, v0
  v_lshrrev_b32 v5, 2, v1
  v_and_b32 v6, 3, v0
  v_and_b32 v7, 1, v2
  v_lshlrev_b32 v8, 13, v2
  v_lshlrev_b32 v9, 2, v2
  s_and_b32 s49, s3, 1
  s_lshl_b32 s49, s49, 1
  v_or_b32 v9, s49, v9
  v_xor_b32 v9, v9, v1
  v_lshl_add_u32 v12, v9, 4, v8
  s_lshl_b32 s49, s3, 16
  v_add_u32 v31, s49, v12
  v_lshrrev_b32 v8, 2, v0
  s_mul_i32 s49, s3, 36
  v_add_u32 v8, s49, v8
  v_lshrrev_b32 v9, 3, v8
  v_and_b32 v9, 1, v9
  v_mul_u32_u24 v9, 3, v9
  v_xor_b32 v9, v9, v6
  v_mul_u32_u24 v8, 1152, v8
  v_lshl_add_u32 v30, v9, 4, v8
  v_lshlrev_b32 v68, 7, v0
  v_lshrrev_b32 v8, 1, v0
  v_lshlrev_b32 v8, 13, v8
  v_and_b32 v9, 1, v0
  v_lshl_add_u32 v69, v9, 7, v8
  s_waitcnt lgkmcnt(0)
  s_lshl_b32 s41, s28, 22
  s_add_u32 s16, s12, s41
  s_addc_u32 s17, s13, 0
  s_add_u32 s12, s6, s41
  s_addc_u32 s13, s7, 0
  s_mov_b32 s8, s14
  s_mov_b32 s9, s15
  s_mov_b32 s26, 4718592
  s_mov_b32 s27, 0x20000
  s_mov_b32 s10, 4718592
  s_mov_b32 s11, 0x20000
  s_mul_i32 s40, s28, 165888
  s_add_u32 s4, s4, s40
  s_addc_u32 s5, s5, 0
  s_sub_u32 s6, 2654208, s40
  s_mov_b32 s7, 0x20000
  s_mov_b32 s22, 18874368
  s_mov_b32 s23, 0x20000
  s_mov_b32 s14, 4194304
  s_mov_b32 s15, 0x20000
  s_mov_b32 s18, 4194304
  s_mov_b32 s19, 0x20000
  s_mov_b32 s31, s29
  s_mov_b32 s30, 0
  s_and_b32 s60, s29, 1
  s_mov_b32 s61, s60
  s_mov_b32 s67, s60
  s_mov_b32 s62, 150528
  s_mov_b32 s51, 16384
  s_mov_b32 s95, 0
  s_mov_b32 s97, 0
  s_add_u32 s55, s31, 16
  s_lshl_b32 s37, s31, 17
  s_add_u32 s37, s37, s38
  s_or_b32 s40, s2, s3
  s_cmp_eq_u32 s40, 0
  s_cbranch_scc0 OP_NN
  s_memrealtime s[40:41]
  s_waitcnt lgkmcnt(0)
  s_or_b32 s40, s40, 1
  v_mov_b32 v244, s40
  v_mov_b32 v245, 0
  s_mov_b64 exec, 1
  global_store_dword v245, v244, s[100:101] sc1
  s_mov_b64 exec, -1
OP_NN:
  s_and_b32 s53, s28, 3
  s_mul_i32 s53, s53, 1179648
  s_lshl_b32 s54, s31, 8
  s_add_u32 s53, s53, s54
  s_lshl_b32 s54, s3, 18
  s_add_u32 s54, s54, s53
  buffer_load_dword v67, v69, s[8:11], s54 offen
  s_cmp_eq_u32 s3, 0
  s_cbranch_scc0 K1_PFXa
  s_add_u32 s54, s53, 1048576
  buffer_load_dword v67, v69, s[8:11], s54 offen
  s_branch K1_PFDa
K1_PFXa:
  s_and_b32 s52, s29, 7
  s_mul_i32 s52, s52, 20736
  s_lshl_b32 s54, s3, 13
  s_add_u32 s52, s52, s54
  s_sub_u32 s52, s52, 8192
  buffer_load_dword v67, v68, s[4:7], s52 offen
K1_PFDa:
  s_cmp_eq_u32 s60, 1
  s_cbranch_scc0 K1_NOPF2
  s_and_b32 s53, s28, 3
  s_mul_i32 s53, s53, 1179648
  s_lshl_b32 s54, s55, 8
  s_add_u32 s53, s53, s54
  s_lshl_b32 s54, s3, 18
  s_add_u32 s54, s54, s53
  buffer_load_dword v67, v69, s[8:11], s54 offen
  s_cmp_eq_u32 s3, 0
  s_cbranch_scc0 K1_PFXc
  s_add_u32 s54, s53, 1048576
  buffer_load_dword v67, v69, s[8:11], s54 offen
  s_branch K1_PFDc
K1_PFXc:
K1_PFDc:
  s_sub_u32 s50, s55, 1
  s_and_b32 s53, s28, 3
  s_mul_i32 s53, s53, 1179648
  s_lshl_b32 s54, s50, 8
  s_add_u32 s53, s53, s54
  s_lshl_b32 s54, s3, 18
  s_add_u32 s54, s54, s53
  buffer_load_dword v67, v69, s[8:11], s54 offen
  s_cmp_eq_u32 s3, 0
  s_cbranch_scc0 K1_PFXd
  s_add_u32 s54, s53, 1048576
  buffer_load_dword v67, v69, s[8:11], s54 offen
  s_branch K1_PFDd
K1_PFXd:
K1_PFDd:
K1_NOPF2:
  s_lshl_b32 s33, s31, 8
  s_add_u32 s63, s33, 31744
  s_mov_b32 s32, 0
  s_mov_b32 s58, 17408
  s_mov_b32 s59, 34816
  s_add_u32 m0, s56, 107520
  s_nop 0
  buffer_load_dwordx4 v31, s[8:11], s33 offen lds
  buffer_load_dwordx4 v31, s[8:11], s63 offen offset:1024 lds
  s_add_u32 m0, s57, 98304
  s_add_u32 s33, s33, 262144
  s_add_u32 s63, s63, 262144
  buffer_load_dwordx4 v30, s[4:7], s32 offen offset:0 lds
  s_add_u32 s32, s32, 64
  buffer_load_dwordx4 v30, s[4:7], s58 offen offset:1024 lds
  s_add_u32 s58, s58, 64
  s_mov_b64 exec, 0xffff
  buffer_load_dwordx4 v30, s[4:7], s59 offen offset:2048 lds
  s_mov_b64 exec, -1
  s_add_u32 s59, s59, 64
  s_add_u32 m0, s56, 124928
  s_nop 0
  buffer_load_dwordx4 v31, s[8:11], s33 offen lds
  buffer_load_dwordx4 v31, s[8:11], s63 offen offset:1024 lds
  s_add_u32 m0, s57, 115712
  s_add_u32 s33, s33, 262144
  s_add_u32 s63, s63, 262144
  buffer_load_dwordx4 v30, s[4:7], s32 offen offset:0 lds
  s_add_u32 s32, s32, 64
  buffer_load_dwordx4 v30, s[4:7], s58 offen offset:1024 lds
  s_add_u32 s58, s58, 64
  s_mov_b64 exec, 0xffff
  buffer_load_dwordx4 v30, s[4:7], s59 offen offset:2048 lds
  s_mov_b64 exec, -1
  s_add_u32 s59, s59, 64
  s_add_u32 m0, s56, 142336
  s_nop 0
  buffer_load_dwordx4 v31, s[8:11], s33 offen lds
  buffer_load_dwordx4 v31, s[8:11], s63 offen offset:1024 lds
  s_add_u32 m0, s57, 133120
  s_add_u32 s33, s33, 262144
  s_add_u32 s63, s63, 262144
  buffer_load_dwordx4 v30, s[4:7], s32 offen offset:0 lds
  s_add_u32 s32, s32, 64
  buffer_load_dwordx4 v30, s[4:7], s58 offen offset:1024 lds
  s_add_u32 s58, s58, 64
  s_mov_b64 exec, 0xffff
  buffer_load_dwordx4 v30, s[4:7], s59 offen offset:2048 lds
  s_mov_b64 exec, -1
  s_add_u32 s59, s59, 64
  v_lshlrev_b32 v8, 8, v3
  v_xor_b32 v9, v4, v1
  v_lshl_add_u32 v8, v9, 4, v8
  s_lshl_b32 s46, s3, 6
  v_xor_b32 v8, s46, v8
  v_xor_b32 v40, 0, v8
  v_xor_b32 v41, 32, v8
  v_xor_b32 v42, 64, v8
  v_xor_b32 v43, 96, v8
  v_xor_b32 v44, 128, v8
  v_xor_b32 v45, 160, v8
  v_xor_b32 v46, 192, v8
  v_xor_b32 v47, 224, v8
  v_lshl_add_u32 v8, v4, 2, v5
  v_lshlrev_b32 v8, 8, v8
  v_add_u32 v8, 49152, v8
  v_lshrrev_b32 v9, 1, v6
  v_lshl_add_u32 v9, v7, 1, v9
  v_lshlrev_b32 v10, 2, v5
  v_lshl_or_b32 v10, v4, 1, v10
  v_xor_b32 v9, v9, v10
  v_lshl_add_u32 v8, v9, 4, v8
  v_and_b32 v9, 1, v6
  v_lshl_add_u32 v8, v9, 3, v8
  v_xor_b32 v48, 0, v8
  v_xor_b32 v49, 64, v8
  v_xor_b32 v50, 128, v8
  v_xor_b32 v51, 192, v8
  v_lshlrev_b32 v8, 8, v1
  v_add_u32 v8, s38, v8
  v_xor_b32 v9, v2, v1
  v_lshl_add_u32 v8, v9, 4, v8
  v_xor_b32 v52, 0, v8
  v_xor_b32 v53, 64, v8
  v_xor_b32 v54, 128, v8
  v_xor_b32 v55, 192, v8
  v_lshl_add_u32 v8, v2, 2, v5
  v_lshlrev_b32 v8, 8, v8
  v_add_u32 v8, s38, v8
  v_add_u32 v8, 49152, v8
  v_lshrrev_b32 v9, 1, v6
  v_lshlrev_b32 v10, 2, v5
  v_lshl_or_b32 v10, v7, 1, v10
  v_xor_b32 v9, v9, v10
  v_lshl_add_u32 v8, v9, 4, v8
  v_and_b32 v9, 1, v6
  v_lshl_add_u32 v8, v9, 3, v8
  v_xor_b32 v56, 0, v8
  v_xor_b32 v57, 32, v8
  v_xor_b32 v58, 64, v8
  v_xor_b32 v59, 96, v8
  v_xor_b32 v60, 128, v8
  v_xor_b32 v61, 160, v8
  v_xor_b32 v62, 192, v8
  v_xor_b32 v63, 224, v8
  v_lshlrev_b32 v8, 8, v2
  v_add_u32 v9, 0, v2
  v_xor_b32 v9, v9, v1
  v_lshl_add_u32 v34, v9, 4, v8
  v_add_u32 v9, 4, v2
  v_xor_b32 v9, v9, v1
  v_lshl_add_u32 v35, v9, 4, v8
  v_add_u32 v9, 8, v2
  v_xor_b32 v9, v9, v1
  v_lshl_add_u32 v36, v9, 4, v8
  v_add_u32 v9, 12, v2
  v_xor_b32 v9, v9, v1
  v_lshl_add_u32 v37, v9, 4, v8
  v_lshlrev_b32 v9, 2, v2
  v_or_b32 v9, 0, v9
  v_xor_b32 v9, v9, v1
  v_lshl_add_u32 v38, v9, 4, v8
  v_lshlrev_b32 v9, 2, v2
  v_or_b32 v9, 2, v9
  v_xor_b32 v9, v9, v1
  v_lshl_add_u32 v39, v9, 4, v8
  v_lshl_add_u32 v8, v2, 3, v5
  v_lshlrev_b32 v8, 8, v8
  v_lshrrev_b32 v9, 1, v6
  v_lshlrev_b32 v10, 2, v5
  v_lshl_or_b32 v10, v7, 1, v10
  v_xor_b32 v9, v9, v10
  v_lshl_add_u32 v8, v9, 4, v8
  v_and_b32 v9, 1, v6
  v_lshl_add_u32 v8, v9, 3, v8
  s_lshl_b32 s49, s3, 6
  v_xor_b32 v8, s49, v8
  v_add_u32 v8, 107520, v8
  v_xor_b32 v22, 0, v8
  v_xor_b32 v23, 32, v8
  v_xor_b32 v24, 64, v8
  v_xor_b32 v25, 96, v8
  v_xor_b32 v26, 128, v8
  v_xor_b32 v27, 160, v8
  v_xor_b32 v28, 192, v8
  v_xor_b32 v29, 224, v8
  v_lshlrev_b32 v8, 6, v1
  v_lshrrev_b32 v9, 3, v1
  v_mul_u32_u24 v9, 3, v9
  v_xor_b32 v9, v9, v2
  v_lshl_add_u32 v8, v9, 4, v8
  v_add_u32 v33, 106496, v8
  v_add_u32 v8, s56, v8
  v_add_u32 v32, 98304, v8
  v_mov_b32 v76, 0
  v_mov_b32 v77, 0
  v_mov_b32 v78, 0
  v_mov_b32 v79, 0
  v_mov_b32 v16, 0
  v_mov_b32 v17, 0
  v_mov_b32 v240, 0
  v_mov_b32 v241, 0
  v_mov_b32 v242, 0
  v_mov_b32 v243, 0
  v_mov_b32 v244, 0
  v_mov_b32 v245, 0
  v_mov_b32 v246, 0
  v_mov_b32 v8, 158720
  ds_write_b64 v8, v[16:17]
K1_Q:
  s_waitcnt vmcnt(10)
  s_barrier
  ds_read_b128 a[144:147], v32 offset:0
  ds_read_b128 a[148:151], v32 offset:1024
  ds_read_b128 a[152:155], v33 offset:0
  ds_read_b64_tr_b16 a[80:81], v22 offset:0
  ds_read_b64_tr_b16 a[82:83], v22 offset:1024
  ds_read_b64_tr_b16 a[84:85], v23 offset:0
  ds_read_b64_tr_b16 a[86:87], v23 offset:1024
  ds_read_b64_tr_b16 a[88:89], v24 offset:0
  ds_read_b64_tr_b16 a[90:91], v24 offset:1024
  ds_read_b64_tr_b16 a[92:93], v25 offset:0
  ds_read_b64_tr_b16 a[94:95], v25 offset:1024
  ds_read_b64_tr_b16 a[96:97], v26 offset:0
  ds_read_b64_tr_b16 a[98:99], v26 offset:1024
  ds_read_b64_tr_b16 a[100:101], v27 offset:0
  ds_read_b64_tr_b16 a[102:103], v27 offset:1024
  ds_read_b64_tr_b16 a[104:105], v28 offset:0
  ds_read_b64_tr_b16 a[106:107], v28 offset:1024
  ds_read_b64_tr_b16 a[108:109], v29 offset:0
  ds_read_b64_tr_b16 a[110:111], v29 offset:1024
  s_waitcnt vmcnt(5) lgkmcnt(0)
  s_barrier
  v_mfma_f32_16x16x32_bf16 v[128:131], a[80:83], a[144:147], 0
  ds_read_b128 a[156:159], v32 offset:17408
  ds_read_b128 a[160:163], v32 offset:18432
  v_mfma_f32_16x16x32_bf16 v[132:135], a[80:83], a[148:151], 0
  ds_read_b128 a[164:167], v33 offset:17408
  ds_read_b64_tr_b16 a[112:113], v22 offset:17408
  s_add_u32 m0, s56, 107520
  v_mfma_f32_16x16x32_bf16 v[192:195], a[80:83], a[152:155], 0
  ds_read_b64_tr_b16 a[114:115], v22 offset:18432
  ds_read_b64_tr_b16 a[116:117], v23 offset:17408
  buffer_load_dwordx4 v31, s[8:11], s33 offen lds
  v_mfma_f32_16x16x32_bf16 v[136:139], a[84:87], a[144:147], 0
  ds_read_b64_tr_b16 a[118:119], v23 offset:18432
  v_mfma_f32_16x16x32_bf16 v[140:143], a[84:87], a[148:151], 0
  ds_read_b64_tr_b16 a[120:121], v24 offset:17408
  v_mfma_f32_16x16x32_bf16 v[196:199], a[84:87], a[152:155], 0
  ds_read_b64_tr_b16 a[122:123], v24 offset:18432
  v_mfma_f32_16x16x32_bf16 v[144:147], a[88:91], a[144:147], 0
  ds_read_b64_tr_b16 a[124:125], v25 offset:17408
  buffer_load_dwordx4 v31, s[8:11], s63 offen offset:1024 lds
  s_add_u32 m0, s57, 98304
  s_add_u32 s33, s33, 262144
  s_add_u32 s63, s63, 262144
  v_mfma_f32_16x16x32_bf16 v[148:151], a[88:91], a[148:151], 0
  ds_read_b64_tr_b16 a[126:127], v25 offset:18432
  v_mfma_f32_16x16x32_bf16 v[152:155], a[92:95], a[144:147], 0
  ds_read_b64_tr_b16 a[128:129], v26 offset:17408
  v_mfma_f32_16x16x32_bf16 v[156:159], a[92:95], a[148:151], 0
  ds_read_b64_tr_b16 a[130:131], v26 offset:18432
  v_mfma_f32_16x16x32_bf16 v[160:163], a[96:99], a[144:147], 0
  ds_read_b64_tr_b16 a[132:133], v27 offset:17408
  buffer_load_dwordx4 v30, s[4:7], s32 offen offset:0 lds
  s_add_u32 s32, s32, 64
  v_mfma_f32_16x16x32_bf16 v[164:167], a[96:99], a[148:151], 0
  ds_read_b64_tr_b16 a[134:135], v27 offset:18432
  v_mfma_f32_16x16x32_bf16 v[168:171], a[100:103], a[144:147], 0
  ds_read_b64_tr_b16 a[136:137], v28 offset:17408
  v_mfma_f32_16x16x32_bf16 v[172:175], a[100:103], a[148:151], 0
  ds_read_b64_tr_b16 a[138:139], v28 offset:18432
  v_mfma_f32_16x16x32_bf16 v[176:179], a[104:107], a[144:147], 0
  ds_read_b64_tr_b16 a[140:141], v29 offset:17408
  buffer_load_dwordx4 v30, s[4:7], s58 offen offset:1024 lds
  s_add_u32 s58, s58, 64
  v_mfma_f32_16x16x32_bf16 v[180:183], a[104:107], a[148:151], 0
  ds_read_b64_tr_b16 a[142:143], v29 offset:18432
  v_mfma_f32_16x16x32_bf16 v[184:187], a[108:111], a[144:147], 0
  v_mfma_f32_16x16x32_bf16 v[188:191], a[108:111], a[148:151], 0
  s_mov_b64 exec, 0xffff
  buffer_load_dwordx4 v30, s[4:7], s59 offen offset:2048 lds
  s_mov_b64 exec, -1
  s_add_u32 s59, s59, 64
  s_waitcnt vmcnt(5) lgkmcnt(0)
  s_barrier
  v_mfma_f32_16x16x32_bf16 v[128:131], a[112:115], a[156:159], v[128:131]
  ds_read_b128 a[144:147], v32 offset:34816
  ds_read_b128 a[148:151], v32 offset:35840
  v_mfma_f32_16x16x32_bf16 v[132:135], a[112:115], a[160:163], v[132:135]
  ds_read_b128 a[152:155], v33 offset:34816
  ds_read_b64_tr_b16 a[80:81], v22 offset:34816
  s_add_u32 m0, s56, 124928
  v_mfma_f32_16x16x32_bf16 v[192:195], a[112:115], a[164:167], v[192:195]
  ds_read_b64_tr_b16 a[82:83], v22 offset:35840
  ds_read_b64_tr_b16 a[84:85], v23 offset:34816
  buffer_load_dwordx4 v31, s[8:11], s33 offen lds
  v_mfma_f32_16x16x32_bf16 v[136:139], a[116:119], a[156:159], v[136:139]
  ds_read_b64_tr_b16 a[86:87], v23 offset:35840
  v_mfma_f32_16x16x32_bf16 v[140:143], a[116:119], a[160:163], v[140:143]
  ds_read_b64_tr_b16 a[88:89], v24 offset:34816
  v_mfma_f32_16x16x32_bf16 v[196:199], a[116:119], a[164:167], v[196:199]
  ds_read_b64_tr_b16 a[90:91], v24 offset:35840
  v_mfma_f32_16x16x32_bf16 v[144:147], a[120:123], a[156:159], v[144:147]
  ds_read_b64_tr_b16 a[92:93], v25 offset:34816
  buffer_load_dwordx4 v31, s[8:11], s63 offen offset:1024 lds
  s_add_u32 m0, s57, 115712
  s_add_u32 s33, s33, 262144
  s_add_u32 s63, s63, 262144
  v_mfma_f32_16x16x32_bf16 v[148:151], a[120:123], a[160:163], v[148:151]
  ds_read_b64_tr_b16 a[94:95], v25 offset:35840
  v_mfma_f32_16x16x32_bf16 v[152:155], a[124:127], a[156:159], v[152:155]
  ds_read_b64_tr_b16 a[96:97], v26 offset:34816
  v_mfma_f32_16x16x32_bf16 v[156:159], a[124:127], a[160:163], v[156:159]
  ds_read_b64_tr_b16 a[98:99], v26 offset:35840
  v_mfma_f32_16x16x32_bf16 v[160:163], a[128:131], a[156:159], v[160:163]
  ds_read_b64_tr_b16 a[100:101], v27 offset:34816
  buffer_load_dwordx4 v30, s[4:7], s32 offen offset:0 lds
  s_add_u32 s32, s32, 64
  v_mfma_f32_16x16x32_bf16 v[164:167], a[128:131], a[160:163], v[164:167]
  ds_read_b64_tr_b16 a[102:103], v27 offset:35840
  v_mfma_f32_16x16x32_bf16 v[168:171], a[132:135], a[156:159], v[168:171]
  ds_read_b64_tr_b16 a[104:105], v28 offset:34816
  v_mfma_f32_16x16x32_bf16 v[172:175], a[132:135], a[160:163], v[172:175]
  ds_read_b64_tr_b16 a[106:107], v28 offset:35840
  v_mfma_f32_16x16x32_bf16 v[176:179], a[136:139], a[156:159], v[176:179]
  ds_read_b64_tr_b16 a[108:109], v29 offset:34816
  buffer_load_dwordx4 v30, s[4:7], s58 offen offset:1024 lds
  s_add_u32 s58, s58, 64
  v_mfma_f32_16x16x32_bf16 v[180:183], a[136:139], a[160:163], v[180:183]
  ds_read_b64_tr_b16 a[110:111], v29 offset:35840
  v_mfma_f32_16x16x32_bf16 v[184:187], a[140:143], a[156:159], v[184:187]
  v_mfma_f32_16x16x32_bf16 v[188:191], a[140:143], a[160:163], v[188:191]
  s_mov_b64 exec, 0xffff
  buffer_load_dwordx4 v30, s[4:7], s59 offen offset:2048 lds
  s_mov_b64 exec, -1
  s_add_u32 s59, s59, 64
  s_waitcnt vmcnt(5) lgkmcnt(0)
  s_barrier
  v_mfma_f32_16x16x32_bf16 v[128:131], a[80:83], a[144:147], v[128:131]
  ds_read_b128 a[156:159], v32 offset:0
  ds_read_b128 a[160:163], v32 offset:1024
  v_mfma_f32_16x16x32_bf16 v[132:135], a[80:83], a[148:151], v[132:135]
  ds_read_b128 a[164:167], v33 offset:0
  ds_read_b64_tr_b16 a[112:113], v22 offset:0
  s_add_u32 m0, s56, 142336
  v_mfma_f32_16x16x32_bf16 v[192:195], a[80:83], a[152:155], v[192:195]
  ds_read_b64_tr_b16 a[114:115], v22 offset:1024
  ds_read_b64_tr_b16 a[116:117], v23 offset:0
  buffer_load_dwordx4 v31, s[8:11], s33 offen lds
  v_mfma_f32_16x16x32_bf16 v[136:139], a[84:87], a[144:147], v[136:139]
  ds_read_b64_tr_b16 a[118:119], v23 offset:1024
  v_mfma_f32_16x16x32_bf16 v[140:143], a[84:87], a[148:151], v[140:143]
  ds_read_b64_tr_b16 a[120:121], v24 offset:0
  v_mfma_f32_16x16x32_bf16 v[196:199], a[84:87], a[152:155], v[196:199]
  ds_read_b64_tr_b16 a[122:123], v24 offset:1024
  v_mfma_f32_16x16x32_bf16 v[144:147], a[88:91], a[144:147], v[144:147]
  ds_read_b64_tr_b16 a[124:125], v25 offset:0
  buffer_load_dwordx4 v31, s[8:11], s63 offen offset:1024 lds
  s_add_u32 m0, s57, 133120
  s_add_u32 s33, s33, 262144
  s_add_u32 s63, s63, 262144
  v_mfma_f32_16x16x32_bf16 v[148:151], a[88:91], a[148:151], v[148:151]
  ds_read_b64_tr_b16 a[126:127], v25 offset:1024
  v_mfma_f32_16x16x32_bf16 v[152:155], a[92:95], a[144:147], v[152:155]
  ds_read_b64_tr_b16 a[128:129], v26 offset:0
  v_mfma_f32_16x16x32_bf16 v[156:159], a[92:95], a[148:151], v[156:159]
  ds_read_b64_tr_b16 a[130:131], v26 offset:1024
  v_mfma_f32_16x16x32_bf16 v[160:163], a[96:99], a[144:147], v[160:163]
  ds_read_b64_tr_b16 a[132:133], v27 offset:0
  buffer_load_dwordx4 v30, s[4:7], s32 offen offset:0 lds
  s_add_u32 s32, s32, 64
  v_mfma_f32_16x16x32_bf16 v[164:167], a[96:99], a[148:151], v[164:167]
  ds_read_b64_tr_b16 a[134:135], v27 offset:1024
  v_mfma_f32_16x16x32_bf16 v[168:171], a[100:103], a[144:147], v[168:171]
  ds_read_b64_tr_b16 a[136:137], v28 offset:0
  v_mfma_f32_16x16x32_bf16 v[172:175], a[100:103], a[148:151], v[172:175]
  ds_read_b64_tr_b16 a[138:139], v28 offset:1024
  v_mfma_f32_16x16x32_bf16 v[176:179], a[104:107], a[144:147], v[176:179]
  ds_read_b64_tr_b16 a[140:141], v29 offset:0
  buffer_load_dwordx4 v30, s[4:7], s58 offen offset:1024 lds
  s_add_u32 s58, s58, 64
  v_mfma_f32_16x16x32_bf16 v[180:183], a[104:107], a[148:151], v[180:183]
  ds_read_b64_tr_b16 a[142:143], v29 offset:1024
  v_mfma_f32_16x16x32_bf16 v[184:187], a[108:111], a[144:147], v[184:187]
  v_mfma_f32_16x16x32_bf16 v[188:191], a[108:111], a[148:151], v[188:191]
  s_mov_b64 exec, 0xffff
  buffer_load_dwordx4 v30, s[4:7], s59 offen offset:2048 lds
  s_mov_b64 exec, -1
  s_add_u32 s59, s59, 64
  s_waitcnt vmcnt(5) lgkmcnt(0)
  s_barrier
  v_mfma_f32_16x16x32_bf16 v[128:131], a[112:115], a[156:159], v[128:131]
  ds_read_b128 a[144:147], v32 offset:17408
  ds_read_b128 a[148:151], v32 offset:18432
  v_mfma_f32_16x16x32_bf16 v[132:135], a[112:115], a[160:163], v[132:135]
  ds_read_b128 a[152:155], v33 offset:17408
  ds_read_b64_tr_b16 a[80:81], v22 offset:17408
  s_add_u32 m0, s56, 107520
  v_mfma_f32_16x16x32_bf16 v[192:195], a[112:115], a[164:167], v[192:195]
  ds_read_b64_tr_b16 a[82:83], v22 offset:18432
  ds_read_b64_tr_b16 a[84:85], v23 offset:17408
  buffer_load_dwordx4 v31, s[8:11], s33 offen lds
  v_mfma_f32_16x16x32_bf16 v[136:139], a[116:119], a[156:159], v[136:139]
  ds_read_b64_tr_b16 a[86:87], v23 offset:18432
  v_mfma_f32_16x16x32_bf16 v[140:143], a[116:119], a[160:163], v[140:143]
  ds_read_b64_tr_b16 a[88:89], v24 offset:17408
  v_mfma_f32_16x16x32_bf16 v[196:199], a[116:119], a[164:167], v[196:199]
  ds_read_b64_tr_b16 a[90:91], v24 offset:18432
  v_mfma_f32_16x16x32_bf16 v[144:147], a[120:123], a[156:159], v[144:147]
  ds_read_b64_tr_b16 a[92:93], v25 offset:17408
  buffer_load_dwordx4 v31, s[8:11], s63 offen offset:1024 lds
  s_add_u32 m0, s57, 98304
  s_add_u32 s33, s33, 262144
  s_add_u32 s63, s63, 262144
  v_mfma_f32_16x16x32_bf16 v[148:151], a[120:123], a[160:163], v[148:151]
  ds_read_b64_tr_b16 a[94:95], v25 offset:18432
  v_mfma_f32_16x16x32_bf16 v[152:155], a[124:127], a[156:159], v[152:155]
  ds_read_b64_tr_b16 a[96:97], v26 offset:17408
  v_mfma_f32_16x16x32_bf16 v[156:159], a[124:127], a[160:163], v[156:159]
  ds_read_b64_tr_b16 a[98:99], v26 offset:18432
  v_mfma_f32_16x16x32_bf16 v[160:163], a[128:131], a[156:159], v[160:163]
  ds_read_b64_tr_b16 a[100:101], v27 offset:17408
  buffer_load_dwordx4 v30, s[4:7], s32 offen offset:0 lds
  s_add_u32 s32, s32, 64
  v_mfma_f32_16x16x32_bf16 v[164:167], a[128:131], a[160:163], v[164:167]
  ds_read_b64_tr_b16 a[102:103], v27 offset:18432
  v_mfma_f32_16x16x32_bf16 v[168:171], a[132:135], a[156:159], v[168:171]
  ds_read_b64_tr_b16 a[104:105], v28 offset:17408
  v_mfma_f32_16x16x32_bf16 v[172:175], a[132:135], a[160:163], v[172:175]
  ds_read_b64_tr_b16 a[106:107], v28 offset:18432
  v_mfma_f32_16x16x32_bf16 v[176:179], a[136:139], a[156:159], v[176:179]
  ds_read_b64_tr_b16 a[108:109], v29 offset:17408
  buffer_load_dwordx4 v30, s[4:7], s58 offen offset:1024 lds
  s_add_u32 s58, s58, 64
  v_mfma_f32_16x16x32_bf16 v[180:183], a[136:139], a[160:163], v[180:183]
  ds_read_b64_tr_b16 a[110:111], v29 offset:18432
  v_mfma_f32_16x16x32_bf16 v[184:187], a[140:143], a[156:159], v[184:187]
  v_mfma_f32_16x16x32_bf16 v[188:191], a[140:143], a[160:163], v[188:191]
  s_mov_b64 exec, 0xffff
  buffer_load_dwordx4 v30, s[4:7], s59 offen offset:2048 lds
  s_mov_b64 exec, -1
  s_add_u32 s59, s59, 64
  s_waitcnt vmcnt(5) lgkmcnt(0)
  s_barrier
  v_mfma_f32_16x16x32_bf16 v[128:131], a[80:83], a[144:147], v[128:131]
  ds_read_b128 a[156:159], v32 offset:34816
  ds_read_b128 a[160:163], v32 offset:35840
  v_mfma_f32_16x16x32_bf16 v[132:135], a[80:83], a[148:151], v[132:135]
  ds_read_b128 a[164:167], v33 offset:34816
  ds_read_b64_tr_b16 a[112:113], v22 offset:34816
  s_add_u32 m0, s56, 124928
  v_mfma_f32_16x16x32_bf16 v[192:195], a[80:83], a[152:155], v[192:195]
  ds_read_b64_tr_b16 a[114:115], v22 offset:35840
  ds_read_b64_tr_b16 a[116:117], v23 offset:34816
  buffer_load_dwordx4 v31, s[8:11], s33 offen lds
  v_mfma_f32_16x16x32_bf16 v[136:139], a[84:87], a[144:147], v[136:139]
  ds_read_b64_tr_b16 a[118:119], v23 offset:35840
  v_mfma_f32_16x16x32_bf16 v[140:143], a[84:87], a[148:151], v[140:143]
  ds_read_b64_tr_b16 a[120:121], v24 offset:34816
  v_mfma_f32_16x16x32_bf16 v[196:199], a[84:87], a[152:155], v[196:199]
  ds_read_b64_tr_b16 a[122:123], v24 offset:35840
  v_mfma_f32_16x16x32_bf16 v[144:147], a[88:91], a[144:147], v[144:147]
  ds_read_b64_tr_b16 a[124:125], v25 offset:34816
  buffer_load_dwordx4 v31, s[8:11], s63 offen offset:1024 lds
  s_add_u32 m0, s57, 115712
  s_add_u32 s33, s33, 262144
  s_add_u32 s63, s63, 262144
  v_mfma_f32_16x16x32_bf16 v[148:151], a[88:91], a[148:151], v[148:151]
  ds_read_b64_tr_b16 a[126:127], v25 offset:35840
  v_mfma_f32_16x16x32_bf16 v[152:155], a[92:95], a[144:147], v[152:155]
  ds_read_b64_tr_b16 a[128:129], v26 offset:34816
  v_mfma_f32_16x16x32_bf16 v[156:159], a[92:95], a[148:151], v[156:159]
  ds_read_b64_tr_b16 a[130:131], v26 offset:35840
  v_mfma_f32_16x16x32_bf16 v[160:163], a[96:99], a[144:147], v[160:163]
  ds_read_b64_tr_b16 a[132:133], v27 offset:34816
  buffer_load_dwordx4 v30, s[4:7], s32 offen offset:0 lds
  s_add_u32 s32, s32, 64
  v_mfma_f32_16x16x32_bf16 v[164:167], a[96:99], a[148:151], v[164:167]
  ds_read_b64_tr_b16 a[134:135], v27 offset:35840
  v_mfma_f32_16x16x32_bf16 v[168:171], a[100:103], a[144:147], v[168:171]
  ds_read_b64_tr_b16 a[136:137], v28 offset:34816
  v_mfma_f32_16x16x32_bf16 v[172:175], a[100:103], a[148:151], v[172:175]
  ds_read_b64_tr_b16 a[138:139], v28 offset:35840
  v_mfma_f32_16x16x32_bf16 v[176:179], a[104:107], a[144:147], v[176:179]
  ds_read_b64_tr_b16 a[140:141], v29 offset:34816
  buffer_load_dwordx4 v30, s[4:7], s58 offen offset:1024 lds
  s_add_u32 s58, s58, 64
  v_mfma_f32_16x16x32_bf16 v[180:183], a[104:107], a[148:151], v[180:183]
  ds_read_b64_tr_b16 a[142:143], v29 offset:35840
  v_mfma_f32_16x16x32_bf16 v[184:187], a[108:111], a[144:147], v[184:187]
  v_mfma_f32_16x16x32_bf16 v[188:191], a[108:111], a[148:151], v[188:191]
  s_mov_b64 exec, 0xffff
  buffer_load_dwordx4 v30, s[4:7], s59 offen offset:2048 lds
  s_mov_b64 exec, -1
  s_add_u32 s59, s59, 64
  s_waitcnt vmcnt(5) lgkmcnt(0)
  s_barrier
  v_mfma_f32_16x16x32_bf16 v[128:131], a[112:115], a[156:159], v[128:131]
  ds_read_b128 a[144:147], v32 offset:0
  ds_read_b128 a[148:151], v32 offset:1024
  v_mfma_f32_16x16x32_bf16 v[132:135], a[112:115], a[160:163], v[132:135]
  ds_read_b128 a[152:155], v33 offset:0
  ds_read_b64_tr_b16 a[80:81], v22 offset:0
  s_add_u32 m0, s56, 142336
  v_mfma_f32_16x16x32_bf16 v[192:195], a[112:115], a[164:167], v[192:195]
  ds_read_b64_tr_b16 a[82:83], v22 offset:1024
  ds_read_b64_tr_b16 a[84:85], v23 offset:0
  buffer_load_dwordx4 v31, s[8:11], s33 offen lds
  v_mfma_f32_16x16x32_bf16 v[136:139], a[116:119], a[156:159], v[136:139]
  ds_read_b64_tr_b16 a[86:87], v23 offset:1024
  v_mfma_f32_16x16x32_bf16 v[140:143], a[116:119], a[160:163], v[140:143]
  ds_read_b64_tr_b16 a[88:89], v24 offset:0
  v_mfma_f32_16x16x32_bf16 v[196:199], a[116:119], a[164:167], v[196:199]
  ds_read_b64_tr_b16 a[90:91], v24 offset:1024
  v_mfma_f32_16x16x32_bf16 v[144:147], a[120:123], a[156:159], v[144:147]
  ds_read_b64_tr_b16 a[92:93], v25 offset:0
  buffer_load_dwordx4 v31, s[8:11], s63 offen offset:1024 lds
  s_add_u32 m0, s57, 133120
  s_add_u32 s33, s33, 262144
  s_add_u32 s63, s63, 262144
  v_mfma_f32_16x16x32_bf16 v[148:151], a[120:123], a[160:163], v[148:151]
  ds_read_b64_tr_b16 a[94:95], v25 offset:1024
  v_mfma_f32_16x16x32_bf16 v[152:155], a[124:127], a[156:159], v[152:155]
  ds_read_b64_tr_b16 a[96:97], v26 offset:0
  v_mfma_f32_16x16x32_bf16 v[156:159], a[124:127], a[160:163], v[156:159]
  ds_read_b64_tr_b16 a[98:99], v26 offset:1024
  v_mfma_f32_16x16x32_bf16 v[160:163], a[128:131], a[156:159], v[160:163]
  ds_read_b64_tr_b16 a[100:101], v27 offset:0
  buffer_load_dwordx4 v30, s[4:7], s32 offen offset:0 lds
  s_add_u32 s32, s32, 64
  v_mfma_f32_16x16x32_bf16 v[164:167], a[128:131], a[160:163], v[164:167]
  ds_read_b64_tr_b16 a[102:103], v27 offset:1024
  v_mfma_f32_16x16x32_bf16 v[168:171], a[132:135], a[156:159], v[168:171]
  ds_read_b64_tr_b16 a[104:105], v28 offset:0
  v_mfma_f32_16x16x32_bf16 v[172:175], a[132:135], a[160:163], v[172:175]
  ds_read_b64_tr_b16 a[106:107], v28 offset:1024
  v_mfma_f32_16x16x32_bf16 v[176:179], a[136:139], a[156:159], v[176:179]
  ds_read_b64_tr_b16 a[108:109], v29 offset:0
  buffer_load_dwordx4 v30, s[4:7], s58 offen offset:1024 lds
  s_add_u32 s58, s58, 64
  v_mfma_f32_16x16x32_bf16 v[180:183], a[136:139], a[160:163], v[180:183]
  ds_read_b64_tr_b16 a[110:111], v29 offset:1024
  v_mfma_f32_16x16x32_bf16 v[184:187], a[140:143], a[156:159], v[184:187]
  v_mfma_f32_16x16x32_bf16 v[188:191], a[140:143], a[160:163], v[188:191]
  s_mov_b64 exec, 0xffff
  buffer_load_dwordx4 v30, s[4:7], s59 offen offset:2048 lds
  s_mov_b64 exec, -1
  s_add_u32 s59, s59, 64
  s_waitcnt vmcnt(5) lgkmcnt(0)
  s_barrier
  v_mfma_f32_16x16x32_bf16 v[128:131], a[80:83], a[144:147], v[128:131]
  ds_read_b128 a[156:159], v32 offset:17408
  ds_read_b128 a[160:163], v32 offset:18432
  v_mfma_f32_16x16x32_bf16 v[132:135], a[80:83], a[148:151], v[132:135]
  ds_read_b128 a[164:167], v33 offset:17408
  ds_read_b64_tr_b16 a[112:113], v22 offset:17408
  s_add_u32 m0, s56, 107520
  v_mfma_f32_16x16x32_bf16 v[192:195], a[80:83], a[152:155], v[192:195]
  ds_read_b64_tr_b16 a[114:115], v22 offset:18432
  ds_read_b64_tr_b16 a[116:117], v23 offset:17408
  buffer_load_dwordx4 v31, s[8:11], s33 offen lds
  v_mfma_f32_16x16x32_bf16 v[136:139], a[84:87], a[144:147], v[136:139]
  ds_read_b64_tr_b16 a[118:119], v23 offset:18432
  v_mfma_f32_16x16x32_bf16 v[140:143], a[84:87], a[148:151], v[140:143]
  ds_read_b64_tr_b16 a[120:121], v24 offset:17408
  v_mfma_f32_16x16x32_bf16 v[196:199], a[84:87], a[152:155], v[196:199]
  ds_read_b64_tr_b16 a[122:123], v24 offset:18432
  v_mfma_f32_16x16x32_bf16 v[144:147], a[88:91], a[144:147], v[144:147]
  ds_read_b64_tr_b16 a[124:125], v25 offset:17408
  buffer_load_dwordx4 v31, s[8:11], s63 offen offset:1024 lds
  s_add_u32 m0, s57, 98304
  s_add_u32 s33, s33, 262144
  s_add_u32 s63, s63, 262144
  v_mfma_f32_16x16x32_bf16 v[148:151], a[88:91], a[148:151], v[148:151]
  ds_read_b64_tr_b16 a[126:127], v25 offset:18432
  v_mfma_f32_16x16x32_bf16 v[152:155], a[92:95], a[144:147], v[152:155]
  ds_read_b64_tr_b16 a[128:129], v26 offset:17408
  v_mfma_f32_16x16x32_bf16 v[156:159], a[92:95], a[148:151], v[156:159]
  ds_read_b64_tr_b16 a[130:131], v26 offset:18432
  v_mfma_f32_16x16x32_bf16 v[160:163], a[96:99], a[144:147], v[160:163]
  ds_read_b64_tr_b16 a[132:133], v27 offset:17408
  buffer_load_dwordx4 v30, s[4:7], s32 offen offset:0 lds
  s_add_u32 s32, s32, 64
  v_mfma_f32_16x16x32_bf16 v[164:167], a[96:99], a[148:151], v[164:167]
  ds_read_b64_tr_b16 a[134:135], v27 offset:18432
  v_mfma_f32_16x16x32_bf16 v[168:171], a[100:103], a[144:147], v[168:171]
  ds_read_b64_tr_b16 a[136:137], v28 offset:17408
  v_mfma_f32_16x16x32_bf16 v[172:175], a[100:103], a[148:151], v[172:175]
  ds_read_b64_tr_b16 a[138:139], v28 offset:18432
  v_mfma_f32_16x16x32_bf16 v[176:179], a[104:107], a[144:147], v[176:179]
  ds_read_b64_tr_b16 a[140:141], v29 offset:17408
  buffer_load_dwordx4 v30, s[4:7], s58 offen offset:1024 lds
  s_add_u32 s58, s58, 64
  v_mfma_f32_16x16x32_bf16 v[180:183], a[104:107], a[148:151], v[180:183]
  ds_read_b64_tr_b16 a[142:143], v29 offset:18432
  v_mfma_f32_16x16x32_bf16 v[184:187], a[108:111], a[144:147], v[184:187]
  v_mfma_f32_16x16x32_bf16 v[188:191], a[108:111], a[148:151], v[188:191]
  s_mov_b64 exec, 0xffff
  buffer_load_dwordx4 v30, s[4:7], s59 offen offset:2048 lds
  s_mov_b64 exec, -1
  s_add_u32 s59, s59, 64
  s_waitcnt vmcnt(5) lgkmcnt(0)
  s_barrier
  v_mfma_f32_16x16x32_bf16 v[128:131], a[112:115], a[156:159], v[128:131]
  ds_read_b128 a[144:147], v32 offset:34816
  ds_read_b128 a[148:151], v32 offset:35840
  v_mfma_f32_16x16x32_bf16 v[132:135], a[112:115], a[160:163], v[132:135]
  ds_read_b128 a[152:155], v33 offset:34816
  ds_read_b64_tr_b16 a[80:81], v22 offset:34816
  s_add_u32 m0, s56, 124928
  v_mfma_f32_16x16x32_bf16 v[192:195], a[112:115], a[164:167], v[192:195]
  ds_read_b64_tr_b16 a[82:83], v22 offset:35840
  ds_read_b64_tr_b16 a[84:85], v23 offset:34816
  buffer_load_dwordx4 v31, s[8:11], s33 offen lds
  v_mfma_f32_16x16x32_bf16 v[136:139], a[116:119], a[156:159], v[136:139]
  ds_read_b64_tr_b16 a[86:87], v23 offset:35840
  v_mfma_f32_16x16x32_bf16 v[140:143], a[116:119], a[160:163], v[140:143]
  ds_read_b64_tr_b16 a[88:89], v24 offset:34816
  v_mfma_f32_16x16x32_bf16 v[196:199], a[116:119], a[164:167], v[196:199]
  ds_read_b64_tr_b16 a[90:91], v24 offset:35840
  v_mfma_f32_16x16x32_bf16 v[144:147], a[120:123], a[156:159], v[144:147]
  ds_read_b64_tr_b16 a[92:93], v25 offset:34816
  buffer_load_dwordx4 v31, s[8:11], s63 offen offset:1024 lds
  s_add_u32 m0, s57, 115712
  s_add_u32 s33, s33, 262144
  s_add_u32 s63, s63, 262144
  v_mfma_f32_16x16x32_bf16 v[148:151], a[120:123], a[160:163], v[148:151]
  ds_read_b64_tr_b16 a[94:95], v25 offset:35840
  v_mfma_f32_16x16x32_bf16 v[152:155], a[124:127], a[156:159], v[152:155]
  ds_read_b64_tr_b16 a[96:97], v26 offset:34816
  v_mfma_f32_16x16x32_bf16 v[156:159], a[124:127], a[160:163], v[156:159]
  ds_read_b64_tr_b16 a[98:99], v26 offset:35840
  v_mfma_f32_16x16x32_bf16 v[160:163], a[128:131], a[156:159], v[160:163]
  ds_read_b64_tr_b16 a[100:101], v27 offset:34816
  buffer_load_dwordx4 v30, s[4:7], s32 offen offset:0 lds
  s_add_u32 s32, s32, 64
  v_mfma_f32_16x16x32_bf16 v[164:167], a[128:131], a[160:163], v[164:167]
  ds_read_b64_tr_b16 a[102:103], v27 offset:35840
  v_mfma_f32_16x16x32_bf16 v[168:171], a[132:135], a[156:159], v[168:171]
  ds_read_b64_tr_b16 a[104:105], v28 offset:34816
  v_mfma_f32_16x16x32_bf16 v[172:175], a[132:135], a[160:163], v[172:175]
  ds_read_b64_tr_b16 a[106:107], v28 offset:35840
  v_mfma_f32_16x16x32_bf16 v[176:179], a[136:139], a[156:159], v[176:179]
  ds_read_b64_tr_b16 a[108:109], v29 offset:34816
  buffer_load_dwordx4 v30, s[4:7], s58 offen offset:1024 lds
  s_add_u32 s58, s58, 64
  v_mfma_f32_16x16x32_bf16 v[180:183], a[136:139], a[160:163], v[180:183]
  ds_read_b64_tr_b16 a[110:111], v29 offset:35840
  v_mfma_f32_16x16x32_bf16 v[184:187], a[140:143], a[156:159], v[184:187]
  v_mfma_f32_16x16x32_bf16 v[188:191], a[140:143], a[160:163], v[188:191]
  s_mov_b64 exec, 0xffff
  buffer_load_dwordx4 v30, s[4:7], s59 offen offset:2048 lds
  s_mov_b64 exec, -1
  s_add_u32 s59, s59, 64
  s_waitcnt vmcnt(5) lgkmcnt(0)
  s_barrier
  v_mfma_f32_16x16x32_bf16 v[128:131], a[80:83], a[144:147], v[128:131]
  ds_read_b128 a[156:159], v32 offset:0
  ds_read_b128 a[160:163], v32 offset:1024
  v_mfma_f32_16x16x32_bf16 v[132:135], a[80:83], a[148:151], v[132:135]
  ds_read_b128 a[164:167], v33 offset:0
  ds_read_b64_tr_b16 a[112:113], v22 offset:0
  s_add_u32 m0, s56, 142336
  v_mfma_f32_16x16x32_bf16 v[192:195], a[80:83], a[152:155], v[192:195]
  ds_read_b64_tr_b16 a[114:115], v22 offset:1024
  ds_read_b64_tr_b16 a[116:117], v23 offset:0
  buffer_load_dwordx4 v31, s[8:11], s33 offen lds
  v_mfma_f32_16x16x32_bf16 v[136:139], a[84:87], a[144:147], v[136:139]
  ds_read_b64_tr_b16 a[118:119], v23 offset:1024
  v_mfma_f32_16x16x32_bf16 v[140:143], a[84:87], a[148:151], v[140:143]
  ds_read_b64_tr_b16 a[120:121], v24 offset:0
  v_mfma_f32_16x16x32_bf16 v[196:199], a[84:87], a[152:155], v[196:199]
  ds_read_b64_tr_b16 a[122:123], v24 offset:1024
  v_mfma_f32_16x16x32_bf16 v[144:147], a[88:91], a[144:147], v[144:147]
  ds_read_b64_tr_b16 a[124:125], v25 offset:0
  buffer_load_dwordx4 v31, s[8:11], s63 offen offset:1024 lds
  s_add_u32 m0, s57, 133120
  s_add_u32 s33, s33, 262144
  s_add_u32 s63, s63, 262144
  v_mfma_f32_16x16x32_bf16 v[148:151], a[88:91], a[148:151], v[148:151]
  ds_read_b64_tr_b16 a[126:127], v25 offset:1024
  v_mfma_f32_16x16x32_bf16 v[152:155], a[92:95], a[144:147], v[152:155]
  ds_read_b64_tr_b16 a[128:129], v26 offset:0
  v_mfma_f32_16x16x32_bf16 v[156:159], a[92:95], a[148:151], v[156:159]
  ds_read_b64_tr_b16 a[130:131], v26 offset:1024
  v_mfma_f32_16x16x32_bf16 v[160:163], a[96:99], a[144:147], v[160:163]
  ds_read_b64_tr_b16 a[132:133], v27 offset:0
  buffer_load_dwordx4 v30, s[4:7], s32 offen offset:0 lds
  s_add_u32 s32, s32, 64
  v_mfma_f32_16x16x32_bf16 v[164:167], a[96:99], a[148:151], v[164:167]
  ds_read_b64_tr_b16 a[134:135], v27 offset:1024
  v_mfma_f32_16x16x32_bf16 v[168:171], a[100:103], a[144:147], v[168:171]
  ds_read_b64_tr_b16 a[136:137], v28 offset:0
  v_mfma_f32_16x16x32_bf16 v[172:175], a[100:103], a[148:151], v[172:175]
  ds_read_b64_tr_b16 a[138:139], v28 offset:1024
  v_mfma_f32_16x16x32_bf16 v[176:179], a[104:107], a[144:147], v[176:179]
  ds_read_b64_tr_b16 a[140:141], v29 offset:0
  buffer_load_dwordx4 v30, s[4:7], s58 offen offset:1024 lds
  s_add_u32 s58, s58, 64
  v_mfma_f32_16x16x32_bf16 v[180:183], a[104:107], a[148:151], v[180:183]
  ds_read_b64_tr_b16 a[142:143], v29 offset:1024
  v_mfma_f32_16x16x32_bf16 v[184:187], a[108:111], a[144:147], v[184:187]
  v_mfma_f32_16x16x32_bf16 v[188:191], a[108:111], a[148:151], v[188:191]
  s_mov_b64 exec, 0xffff
  buffer_load_dwordx4 v30, s[4:7], s59 offen offset:2048 lds
  s_mov_b64 exec, -1
  s_add_u32 s59, s59, 64
  s_waitcnt vmcnt(5) lgkmcnt(0)
  s_barrier
  v_mfma_f32_16x16x32_bf16 v[128:131], a[112:115], a[156:159], v[128:131]
  ds_read_b128 a[144:147], v32 offset:17408
  ds_read_b128 a[148:151], v32 offset:18432
  v_mfma_f32_16x16x32_bf16 v[132:135], a[112:115], a[160:163], v[132:135]
  ds_read_b128 a[152:155], v33 offset:17408
  ds_read_b64_tr_b16 a[80:81], v22 offset:17408
  s_add_u32 m0, s56, 107520
  v_mfma_f32_16x16x32_bf16 v[192:195], a[112:115], a[164:167], v[192:195]
  ds_read_b64_tr_b16 a[82:83], v22 offset:18432
  ds_read_b64_tr_b16 a[84:85], v23 offset:17408
  buffer_load_dwordx4 v31, s[8:11], s33 offen lds
  v_mfma_f32_16x16x32_bf16 v[136:139], a[116:119], a[156:159], v[136:139]
  ds_read_b64_tr_b16 a[86:87], v23 offset:18432
  v_mfma_f32_16x16x32_bf16 v[140:143], a[116:119], a[160:163], v[140:143]
  ds_read_b64_tr_b16 a[88:89], v24 offset:17408
  v_mfma_f32_16x16x32_bf16 v[196:199], a[116:119], a[164:167], v[196:199]
  ds_read_b64_tr_b16 a[90:91], v24 offset:18432
  v_mfma_f32_16x16x32_bf16 v[144:147], a[120:123], a[156:159], v[144:147]
  ds_read_b64_tr_b16 a[92:93], v25 offset:17408
  buffer_load_dwordx4 v31, s[8:11], s63 offen offset:1024 lds
  s_add_u32 m0, s57, 98304
  s_add_u32 s33, s33, 262144
  s_add_u32 s63, s63, 262144
  v_mfma_f32_16x16x32_bf16 v[148:151], a[120:123], a[160:163], v[148:151]
  ds_read_b64_tr_b16 a[94:95], v25 offset:18432
  v_mfma_f32_16x16x32_bf16 v[152:155], a[124:127], a[156:159], v[152:155]
  ds_read_b64_tr_b16 a[96:97], v26 offset:17408
  v_mfma_f32_16x16x32_bf16 v[156:159], a[124:127], a[160:163], v[156:159]
  ds_read_b64_tr_b16 a[98:99], v26 offset:18432
  v_mfma_f32_16x16x32_bf16 v[160:163], a[128:131], a[156:159], v[160:163]
  ds_read_b64_tr_b16 a[100:101], v27 offset:17408
  buffer_load_dwordx4 v30, s[4:7], s32 offen offset:0 lds
  s_add_u32 s32, s32, 64
  v_mfma_f32_16x16x32_bf16 v[164:167], a[128:131], a[160:163], v[164:167]
  ds_read_b64_tr_b16 a[102:103], v27 offset:18432
  v_mfma_f32_16x16x32_bf16 v[168:171], a[132:135], a[156:159], v[168:171]
  ds_read_b64_tr_b16 a[104:105], v28 offset:17408
  v_mfma_f32_16x16x32_bf16 v[172:175], a[132:135], a[160:163], v[172:175]
  ds_read_b64_tr_b16 a[106:107], v28 offset:18432
  v_mfma_f32_16x16x32_bf16 v[176:179], a[136:139], a[156:159], v[176:179]
  ds_read_b64_tr_b16 a[108:109], v29 offset:17408
  buffer_load_dwordx4 v30, s[4:7], s58 offen offset:1024 lds
  s_add_u32 s58, s58, 64
  v_mfma_f32_16x16x32_bf16 v[180:183], a[136:139], a[160:163], v[180:183]
  ds_read_b64_tr_b16 a[110:111], v29 offset:18432
  v_mfma_f32_16x16x32_bf16 v[184:187], a[140:143], a[156:159], v[184:187]
  v_mfma_f32_16x16x32_bf16 v[188:191], a[140:143], a[160:163], v[188:191]
  s_mov_b64 exec, 0xffff
  buffer_load_dwordx4 v30, s[4:7], s59 offen offset:2048 lds
  s_mov_b64 exec, -1
  s_add_u32 s59, s59, 64
  s_waitcnt vmcnt(5) lgkmcnt(0)
  s_barrier
  v_mfma_f32_16x16x32_bf16 v[128:131], a[80:83], a[144:147], v[128:131]
  ds_read_b128 a[156:159], v32 offset:34816
  ds_read_b128 a[160:163], v32 offset:35840
  v_mfma_f32_16x16x32_bf16 v[132:135], a[80:83], a[148:151], v[132:135]
  ds_read_b128 a[164:167], v33 offset:34816
  ds_read_b64_tr_b16 a[112:113], v22 offset:34816
  s_add_u32 m0, s56, 124928
  v_mfma_f32_16x16x32_bf16 v[192:195], a[80:83], a[152:155], v[192:195]
  ds_read_b64_tr_b16 a[114:115], v22 offset:35840
  ds_read_b64_tr_b16 a[116:117], v23 offset:34816
  buffer_load_dwordx4 v31, s[8:11], s33 offen lds
  v_mfma_f32_16x16x32_bf16 v[136:139], a[84:87], a[144:147], v[136:139]
  ds_read_b64_tr_b16 a[118:119], v23 offset:35840
  v_mfma_f32_16x16x32_bf16 v[140:143], a[84:87], a[148:151], v[140:143]
  ds_read_b64_tr_b16 a[120:121], v24 offset:34816
  v_mfma_f32_16x16x32_bf16 v[196:199], a[84:87], a[152:155], v[196:199]
  ds_read_b64_tr_b16 a[122:123], v24 offset:35840
  v_mfma_f32_16x16x32_bf16 v[144:147], a[88:91], a[144:147], v[144:147]
  ds_read_b64_tr_b16 a[124:125], v25 offset:34816
  buffer_load_dwordx4 v31, s[8:11], s63 offen offset:1024 lds
  s_add_u32 m0, s57, 115712
  s_add_u32 s33, s33, 262144
  s_add_u32 s63, s63, 262144
  v_mfma_f32_16x16x32_bf16 v[148:151], a[88:91], a[148:151], v[148:151]
  ds_read_b64_tr_b16 a[126:127], v25 offset:35840
  v_mfma_f32_16x16x32_bf16 v[152:155], a[92:95], a[144:147], v[152:155]
  ds_read_b64_tr_b16 a[128:129], v26 offset:34816
  v_mfma_f32_16x16x32_bf16 v[156:159], a[92:95], a[148:151], v[156:159]
  ds_read_b64_tr_b16 a[130:131], v26 offset:35840
  v_mfma_f32_16x16x32_bf16 v[160:163], a[96:99], a[144:147], v[160:163]
  ds_read_b64_tr_b16 a[132:133], v27 offset:34816
  buffer_load_dwordx4 v30, s[4:7], s32 offen offset:0 lds
  s_add_u32 s32, s32, 64
  v_mfma_f32_16x16x32_bf16 v[164:167], a[96:99], a[148:151], v[164:167]
  ds_read_b64_tr_b16 a[134:135], v27 offset:35840
  v_mfma_f32_16x16x32_bf16 v[168:171], a[100:103], a[144:147], v[168:171]
  ds_read_b64_tr_b16 a[136:137], v28 offset:34816
  v_mfma_f32_16x16x32_bf16 v[172:175], a[100:103], a[148:151], v[172:175]
  ds_read_b64_tr_b16 a[138:139], v28 offset:35840
  v_mfma_f32_16x16x32_bf16 v[176:179], a[104:107], a[144:147], v[176:179]
  ds_read_b64_tr_b16 a[140:141], v29 offset:34816
  buffer_load_dwordx4 v30, s[4:7], s58 offen offset:1024 lds
  s_add_u32 s58, s58, 64
  v_mfma_f32_16x16x32_bf16 v[180:183], a[104:107], a[148:151], v[180:183]
  ds_read_b64_tr_b16 a[142:143], v29 offset:35840
  v_mfma_f32_16x16x32_bf16 v[184:187], a[108:111], a[144:147], v[184:187]
  v_mfma_f32_16x16x32_bf16 v[188:191], a[108:111], a[148:151], v[188:191]
  s_mov_b64 exec, 0xffff
  buffer_load_dwordx4 v30, s[4:7], s59 offen offset:2048 lds
  s_mov_b64 exec, -1
  s_add_u32 s59, s59, 64
  s_waitcnt vmcnt(5) lgkmcnt(0)
  s_barrier
  v_mfma_f32_16x16x32_bf16 v[128:131], a[112:115], a[156:159], v[128:131]
  ds_read_b128 a[144:147], v32 offset:0
  ds_read_b128 a[148:151], v32 offset:1024
  v_mfma_f32_16x16x32_bf16 v[132:135], a[112:115], a[160:163], v[132:135]
  ds_read_b128 a[152:155], v33 offset:0
  ds_read_b64_tr_b16 a[80:81], v22 offset:0
  s_add_u32 m0, s56, 142336
  v_mfma_f32_16x16x32_bf16 v[192:195], a[112:115], a[164:167], v[192:195]
  ds_read_b64_tr_b16 a[82:83], v22 offset:1024
  ds_read_b64_tr_b16 a[84:85], v23 offset:0
  buffer_load_dwordx4 v31, s[8:11], s33 offen lds
  v_mfma_f32_16x16x32_bf16 v[136:139], a[116:119], a[156:159], v[136:139]
  ds_read_b64_tr_b16 a[86:87], v23 offset:1024
  v_mfma_f32_16x16x32_bf16 v[140:143], a[116:119], a[160:163], v[140:143]
  ds_read_b64_tr_b16 a[88:89], v24 offset:0
  v_mfma_f32_16x16x32_bf16 v[196:199], a[116:119], a[164:167], v[196:199]
  ds_read_b64_tr_b16 a[90:91], v24 offset:1024
  v_mfma_f32_16x16x32_bf16 v[144:147], a[120:123], a[156:159], v[144:147]
  ds_read_b64_tr_b16 a[92:93], v25 offset:0
  buffer_load_dwordx4 v31, s[8:11], s63 offen offset:1024 lds
  s_add_u32 m0, s57, 133120
  s_add_u32 s33, s33, 262144
  s_add_u32 s63, s63, 262144
  v_mfma_f32_16x16x32_bf16 v[148:151], a[120:123], a[160:163], v[148:151]
  ds_read_b64_tr_b16 a[94:95], v25 offset:1024
  v_mfma_f32_16x16x32_bf16 v[152:155], a[124:127], a[156:159], v[152:155]
  ds_read_b64_tr_b16 a[96:97], v26 offset:0
  v_mfma_f32_16x16x32_bf16 v[156:159], a[124:127], a[160:163], v[156:159]
  ds_read_b64_tr_b16 a[98:99], v26 offset:1024
  v_mfma_f32_16x16x32_bf16 v[160:163], a[128:131], a[156:159], v[160:163]
  ds_read_b64_tr_b16 a[100:101], v27 offset:0
  buffer_load_dwordx4 v30, s[4:7], s32 offen offset:0 lds
  s_add_u32 s32, s32, 64
  v_mfma_f32_16x16x32_bf16 v[164:167], a[128:131], a[160:163], v[164:167]
  ds_read_b64_tr_b16 a[102:103], v27 offset:1024
  v_mfma_f32_16x16x32_bf16 v[168:171], a[132:135], a[156:159], v[168:171]
  ds_read_b64_tr_b16 a[104:105], v28 offset:0
  v_mfma_f32_16x16x32_bf16 v[172:175], a[132:135], a[160:163], v[172:175]
  ds_read_b64_tr_b16 a[106:107], v28 offset:1024
  v_mfma_f32_16x16x32_bf16 v[176:179], a[136:139], a[156:159], v[176:179]
  ds_read_b64_tr_b16 a[108:109], v29 offset:0
  buffer_load_dwordx4 v30, s[4:7], s58 offen offset:1024 lds
  s_add_u32 s58, s58, 64
  v_mfma_f32_16x16x32_bf16 v[180:183], a[136:139], a[160:163], v[180:183]
  ds_read_b64_tr_b16 a[110:111], v29 offset:1024
  v_mfma_f32_16x16x32_bf16 v[184:187], a[140:143], a[156:159], v[184:187]
  v_mfma_f32_16x16x32_bf16 v[188:191], a[140:143], a[160:163], v[188:191]
  s_mov_b64 exec, 0xffff
  buffer_load_dwordx4 v30, s[4:7], s59 offen offset:2048 lds
  s_mov_b64 exec, -1
  s_add_u32 s59, s59, 64
  s_waitcnt vmcnt(5) lgkmcnt(0)
  s_barrier
  v_mfma_f32_16x16x32_bf16 v[128:131], a[80:83], a[144:147], v[128:131]
  ds_read_b128 a[156:159], v32 offset:17408
  ds_read_b128 a[160:163], v32 offset:18432
  v_mfma_f32_16x16x32_bf16 v[132:135], a[80:83], a[148:151], v[132:135]
  ds_read_b128 a[164:167], v33 offset:17408
  ds_read_b64_tr_b16 a[112:113], v22 offset:17408
  s_add_u32 m0, s56, 107520
  v_mfma_f32_16x16x32_bf16 v[192:195], a[80:83], a[152:155], v[192:195]
  ds_read_b64_tr_b16 a[114:115], v22 offset:18432
  ds_read_b64_tr_b16 a[116:117], v23 offset:17408
  buffer_load_dwordx4 v31, s[8:11], s33 offen lds
  v_mfma_f32_16x16x32_bf16 v[136:139], a[84:87], a[144:147], v[136:139]
  ds_read_b64_tr_b16 a[118:119], v23 offset:18432
  v_mfma_f32_16x16x32_bf16 v[140:143], a[84:87], a[148:151], v[140:143]
  ds_read_b64_tr_b16 a[120:121], v24 offset:17408
  v_mfma_f32_16x16x32_bf16 v[196:199], a[84:87], a[152:155], v[196:199]
  ds_read_b64_tr_b16 a[122:123], v24 offset:18432
  v_mfma_f32_16x16x32_bf16 v[144:147], a[88:91], a[144:147], v[144:147]
  ds_read_b64_tr_b16 a[124:125], v25 offset:17408
  buffer_load_dwordx4 v31, s[8:11], s63 offen offset:1024 lds
  s_add_u32 m0, s57, 98304
  s_add_u32 s33, s33, 262144
  s_add_u32 s63, s63, 262144
  v_mfma_f32_16x16x32_bf16 v[148:151], a[88:91], a[148:151], v[148:151]
  ds_read_b64_tr_b16 a[126:127], v25 offset:18432
  v_mfma_f32_16x16x32_bf16 v[152:155], a[92:95], a[144:147], v[152:155]
  ds_read_b64_tr_b16 a[128:129], v26 offset:17408
  v_mfma_f32_16x16x32_bf16 v[156:159], a[92:95], a[148:151], v[156:159]
  ds_read_b64_tr_b16 a[130:131], v26 offset:18432
  v_mfma_f32_16x16x32_bf16 v[160:163], a[96:99], a[144:147], v[160:163]
  ds_read_b64_tr_b16 a[132:133], v27 offset:17408
  buffer_load_dwordx4 v30, s[4:7], s32 offen offset:0 lds
  s_add_u32 s32, s32, 64
  v_mfma_f32_16x16x32_bf16 v[164:167], a[96:99], a[148:151], v[164:167]
  ds_read_b64_tr_b16 a[134:135], v27 offset:18432
  v_mfma_f32_16x16x32_bf16 v[168:171], a[100:103], a[144:147], v[168:171]
  ds_read_b64_tr_b16 a[136:137], v28 offset:17408
  v_mfma_f32_16x16x32_bf16 v[172:175], a[100:103], a[148:151], v[172:175]
  ds_read_b64_tr_b16 a[138:139], v28 offset:18432
  v_mfma_f32_16x16x32_bf16 v[176:179], a[104:107], a[144:147], v[176:179]
  ds_read_b64_tr_b16 a[140:141], v29 offset:17408
  buffer_load_dwordx4 v30, s[4:7], s58 offen offset:1024 lds
  s_add_u32 s58, s58, 64
  v_mfma_f32_16x16x32_bf16 v[180:183], a[104:107], a[148:151], v[180:183]
  ds_read_b64_tr_b16 a[142:143], v29 offset:18432
  v_mfma_f32_16x16x32_bf16 v[184:187], a[108:111], a[144:147], v[184:187]
  v_mfma_f32_16x16x32_bf16 v[188:191], a[108:111], a[148:151], v[188:191]
  s_mov_b64 exec, 0xffff
  buffer_load_dwordx4 v30, s[4:7], s59 offen offset:2048 lds
  s_mov_b64 exec, -1
  s_add_u32 s59, s59, 64
  s_waitcnt vmcnt(5) lgkmcnt(0)
  s_barrier
  v_mfma_f32_16x16x32_bf16 v[128:131], a[112:115], a[156:159], v[128:131]
  ds_read_b128 a[144:147], v32 offset:34816
  ds_read_b128 a[148:151], v32 offset:35840
  v_mfma_f32_16x16x32_bf16 v[132:135], a[112:115], a[160:163], v[132:135]
  ds_read_b128 a[152:155], v33 offset:34816
  ds_read_b64_tr_b16 a[80:81], v22 offset:34816
  s_add_u32 m0, s56, 124928
  v_mfma_f32_16x16x32_bf16 v[192:195], a[112:115], a[164:167], v[192:195]
  ds_read_b64_tr_b16 a[82:83], v22 offset:35840
  ds_read_b64_tr_b16 a[84:85], v23 offset:34816
  buffer_load_dwordx4 v31, s[8:11], s33 offen lds
  v_mfma_f32_16x16x32_bf16 v[136:139], a[116:119], a[156:159], v[136:139]
  ds_read_b64_tr_b16 a[86:87], v23 offset:35840
  v_mfma_f32_16x16x32_bf16 v[140:143], a[116:119], a[160:163], v[140:143]
  ds_read_b64_tr_b16 a[88:89], v24 offset:34816
  v_mfma_f32_16x16x32_bf16 v[196:199], a[116:119], a[164:167], v[196:199]
  ds_read_b64_tr_b16 a[90:91], v24 offset:35840
  v_mfma_f32_16x16x32_bf16 v[144:147], a[120:123], a[156:159], v[144:147]
  ds_read_b64_tr_b16 a[92:93], v25 offset:34816
  buffer_load_dwordx4 v31, s[8:11], s63 offen offset:1024 lds
  s_add_u32 m0, s57, 115712
  s_add_u32 s33, s33, 262144
  s_add_u32 s63, s63, 262144
  v_mfma_f32_16x16x32_bf16 v[148:151], a[120:123], a[160:163], v[148:151]
  ds_read_b64_tr_b16 a[94:95], v25 offset:35840
  v_mfma_f32_16x16x32_bf16 v[152:155], a[124:127], a[156:159], v[152:155]
  ds_read_b64_tr_b16 a[96:97], v26 offset:34816
  v_mfma_f32_16x16x32_bf16 v[156:159], a[124:127], a[160:163], v[156:159]
  ds_read_b64_tr_b16 a[98:99], v26 offset:35840
  v_mfma_f32_16x16x32_bf16 v[160:163], a[128:131], a[156:159], v[160:163]
  ds_read_b64_tr_b16 a[100:101], v27 offset:34816
  buffer_load_dwordx4 v30, s[4:7], s32 offen offset:0 lds
  s_add_u32 s32, s32, 64
  v_mfma_f32_16x16x32_bf16 v[164:167], a[128:131], a[160:163], v[164:167]
  ds_read_b64_tr_b16 a[102:103], v27 offset:35840
  v_mfma_f32_16x16x32_bf16 v[168:171], a[132:135], a[156:159], v[168:171]
  ds_read_b64_tr_b16 a[104:105], v28 offset:34816
  v_mfma_f32_16x16x32_bf16 v[172:175], a[132:135], a[160:163], v[172:175]
  ds_read_b64_tr_b16 a[106:107], v28 offset:35840
  v_mfma_f32_16x16x32_bf16 v[176:179], a[136:139], a[156:159], v[176:179]
  ds_read_b64_tr_b16 a[108:109], v29 offset:34816
  buffer_load_dwordx4 v30, s[4:7], s58 offen offset:1024 lds
  s_add_u32 s58, s58, 64
  v_mfma_f32_16x16x32_bf16 v[180:183], a[136:139], a[160:163], v[180:183]
  ds_read_b64_tr_b16 a[110:111], v29 offset:35840
  v_mfma_f32_16x16x32_bf16 v[184:187], a[140:143], a[156:159], v[184:187]
  v_mfma_f32_16x16x32_bf16 v[188:191], a[140:143], a[160:163], v[188:191]
  s_mov_b64 exec, 0xffff
  buffer_load_dwordx4 v30, s[4:7], s59 offen offset:2048 lds
  s_mov_b64 exec, -1
  s_add_u32 s59, s59, 64
  s_waitcnt vmcnt(5) lgkmcnt(0)
  s_barrier
  v_mfma_f32_16x16x32_bf16 v[128:131], a[80:83], a[144:147], v[128:131]
  ds_read_b128 a[156:159], v32 offset:0
  ds_read_b128 a[160:163], v32 offset:1024
  v_mfma_f32_16x16x32_bf16 v[132:135], a[80:83], a[148:151], v[132:135]
  ds_read_b128 a[164:167], v33 offset:0
  ds_read_b64_tr_b16 a[112:113], v22 offset:0
  s_add_u32 m0, s56, 142336
  v_mfma_f32_16x16x32_bf16 v[192:195], a[80:83], a[152:155], v[192:195]
  ds_read_b64_tr_b16 a[114:115], v22 offset:1024
  ds_read_b64_tr_b16 a[116:117], v23 offset:0
  buffer_load_dwordx4 v31, s[8:11], s33 offen lds
  v_mfma_f32_16x16x32_bf16 v[136:139], a[84:87], a[144:147], v[136:139]
  ds_read_b64_tr_b16 a[118:119], v23 offset:1024
  v_mfma_f32_16x16x32_bf16 v[140:143], a[84:87], a[148:151], v[140:143]
  ds_read_b64_tr_b16 a[120:121], v24 offset:0
  v_mfma_f32_16x16x32_bf16 v[196:199], a[84:87], a[152:155], v[196:199]
  ds_read_b64_tr_b16 a[122:123], v24 offset:1024
  v_mfma_f32_16x16x32_bf16 v[144:147], a[88:91], a[144:147], v[144:147]
  ds_read_b64_tr_b16 a[124:125], v25 offset:0
  buffer_load_dwordx4 v31, s[8:11], s63 offen offset:1024 lds
  s_add_u32 m0, s57, 133120
  s_add_u32 s33, s33, 262144
  s_add_u32 s63, s63, 262144
  v_mfma_f32_16x16x32_bf16 v[148:151], a[88:91], a[148:151], v[148:151]
  ds_read_b64_tr_b16 a[126:127], v25 offset:1024
  v_mfma_f32_16x16x32_bf16 v[152:155], a[92:95], a[144:147], v[152:155]
  ds_read_b64_tr_b16 a[128:129], v26 offset:0
  v_mfma_f32_16x16x32_bf16 v[156:159], a[92:95], a[148:151], v[156:159]
  ds_read_b64_tr_b16 a[130:131], v26 offset:1024
  v_mfma_f32_16x16x32_bf16 v[160:163], a[96:99], a[144:147], v[160:163]
  ds_read_b64_tr_b16 a[132:133], v27 offset:0
  buffer_load_dwordx4 v30, s[4:7], s32 offen offset:0 lds
  s_add_u32 s32, s32, 64
  v_mfma_f32_16x16x32_bf16 v[164:167], a[96:99], a[148:151], v[164:167]
  ds_read_b64_tr_b16 a[134:135], v27 offset:1024
  v_mfma_f32_16x16x32_bf16 v[168:171], a[100:103], a[144:147], v[168:171]
  ds_read_b64_tr_b16 a[136:137], v28 offset:0
  v_mfma_f32_16x16x32_bf16 v[172:175], a[100:103], a[148:151], v[172:175]
  ds_read_b64_tr_b16 a[138:139], v28 offset:1024
  v_mfma_f32_16x16x32_bf16 v[176:179], a[104:107], a[144:147], v[176:179]
  ds_read_b64_tr_b16 a[140:141], v29 offset:0
  buffer_load_dwordx4 v30, s[4:7], s58 offen offset:1024 lds
  s_add_u32 s58, s58, 64
  v_mfma_f32_16x16x32_bf16 v[180:183], a[104:107], a[148:151], v[180:183]
  ds_read_b64_tr_b16 a[142:143], v29 offset:1024
  v_mfma_f32_16x16x32_bf16 v[184:187], a[108:111], a[144:147], v[184:187]
  v_mfma_f32_16x16x32_bf16 v[188:191], a[108:111], a[148:151], v[188:191]
  s_mov_b64 exec, 0xffff
  buffer_load_dwordx4 v30, s[4:7], s59 offen offset:2048 lds
  s_mov_b64 exec, -1
  s_add_u32 s59, s59, 64
  s_cmp_eq_u32 s67, 1
  s_cbranch_scc1 K1_QT_NEXT
  s_cmp_eq_u32 s67, 2
  s_cbranch_scc1 K1_QT_ST
  s_waitcnt vmcnt(5) lgkmcnt(0)
  s_barrier
  v_mfma_f32_16x16x32_bf16 v[128:131], a[112:115], a[156:159], v[128:131]
  ds_read_b128 a[144:147], v32 offset:17408
  ds_read_b128 a[148:151], v32 offset:18432
  v_mfma_f32_16x16x32_bf16 v[132:135], a[112:115], a[160:163], v[132:135]
  ds_read_b128 a[152:155], v33 offset:17408
  ds_read_b64_tr_b16 a[80:81], v22 offset:17408
  s_add_u32 m0, s38, 0
  s_add_u32 s50, s37, 0
  v_mfma_f32_16x16x32_bf16 v[192:195], a[112:115], a[164:167], v[192:195]
  ds_read_b64_tr_b16 a[82:83], v22 offset:18432
  ds_read_b64_tr_b16 a[84:85], v23 offset:17408
  buffer_load_dwordx4 v34, s[12:15], s50 offen offset:0 nt lds
  v_mfma_f32_16x16x32_bf16 v[136:139], a[116:119], a[156:159], v[136:139]
  ds_read_b64_tr_b16 a[86:87], v23 offset:18432
  v_mfma_f32_16x16x32_bf16 v[140:143], a[116:119], a[160:163], v[140:143]
  ds_read_b64_tr_b16 a[88:89], v24 offset:17408
  v_mfma_f32_16x16x32_bf16 v[196:199], a[116:119], a[164:167], v[196:199]
  ds_read_b64_tr_b16 a[90:91], v24 offset:18432
  v_mfma_f32_16x16x32_bf16 v[144:147], a[120:123], a[156:159], v[144:147]
  ds_read_b64_tr_b16 a[92:93], v25 offset:17408
  buffer_load_dwordx4 v35, s[12:15], s50 offen offset:1024 nt lds
  v_mfma_f32_16x16x32_bf16 v[148:151], a[120:123], a[160:163], v[148:151]
  ds_read_b64_tr_b16 a[94:95], v25 offset:18432
  v_mfma_f32_16x16x32_bf16 v[152:155], a[124:127], a[156:159], v[152:155]
  ds_read_b64_tr_b16 a[96:97], v26 offset:17408
  v_mfma_f32_16x16x32_bf16 v[156:159], a[124:127], a[160:163], v[156:159]
  ds_read_b64_tr_b16 a[98:99], v26 offset:18432
  v_mfma_f32_16x16x32_bf16 v[160:163], a[128:131], a[156:159], v[160:163]
  ds_read_b64_tr_b16 a[100:101], v27 offset:17408
  buffer_load_dwordx4 v36, s[12:15], s50 offen offset:2048 nt lds
  v_mfma_f32_16x16x32_bf16 v[164:167], a[128:131], a[160:163], v[164:167]
  ds_read_b64_tr_b16 a[102:103], v27 offset:18432
  v_mfma_f32_16x16x32_bf16 v[168:171], a[132:135], a[156:159], v[168:171]
  ds_read_b64_tr_b16 a[104:105], v28 offset:17408
  v_mfma_f32_16x16x32_bf16 v[172:175], a[132:135], a[160:163], v[172:175]
  ds_read_b64_tr_b16 a[106:107], v28 offset:18432
  v_mfma_f32_16x16x32_bf16 v[176:179], a[136:139], a[156:159], v[176:179]
  ds_read_b64_tr_b16 a[108:109], v29 offset:17408
  buffer_load_dwordx4 v37, s[12:15], s50 offen offset:3072 nt lds
  v_mfma_f32_16x16x32_bf16 v[180:183], a[136:139], a[160:163], v[180:183]
  ds_read_b64_tr_b16 a[110:111], v29 offset:18432
  v_mfma_f32_16x16x32_bf16 v[184:187], a[140:143], a[156:159], v[184:187]
  s_add_u32 m0, s38, 49152
  s_add_u32 s50, s37, 0
  v_mfma_f32_16x16x32_bf16 v[188:191], a[140:143], a[160:163], v[188:191]
  buffer_load_dwordx4 v38, s[16:19], s50 offen offset:0 nt lds
  s_waitcnt vmcnt(5) lgkmcnt(0)
  s_barrier
  v_mfma_f32_16x16x32_bf16 v[128:131], a[80:83], a[144:147], v[128:131]
  ds_read_b128 a[156:159], v32 offset:34816
  ds_read_b128 a[160:163], v32 offset:35840
  v_mfma_f32_16x16x32_bf16 v[132:135], a[80:83], a[148:151], v[132:135]
  ds_read_b128 a[164:167], v33 offset:34816
  ds_read_b64_tr_b16 a[112:113], v22 offset:34816
  v_mfma_f32_16x16x32_bf16 v[192:195], a[80:83], a[152:155], v[192:195]
  ds_read_b64_tr_b16 a[114:115], v22 offset:35840
  ds_read_b64_tr_b16 a[116:117], v23 offset:34816
  buffer_load_dwordx4 v39, s[16:19], s50 offen offset:1024 nt lds
  v_mfma_f32_16x16x32_bf16 v[136:139], a[84:87], a[144:147], v[136:139]
  ds_read_b64_tr_b16 a[118:119], v23 offset:35840
  v_mfma_f32_16x16x32_bf16 v[140:143], a[84:87], a[148:151], v[140:143]
  ds_read_b64_tr_b16 a[120:121], v24 offset:34816
  v_mfma_f32_16x16x32_bf16 v[196:199], a[84:87], a[152:155], v[196:199]
  ds_read_b64_tr_b16 a[122:123], v24 offset:35840
  v_mfma_f32_16x16x32_bf16 v[144:147], a[88:91], a[144:147], v[144:147]
  ds_read_b64_tr_b16 a[124:125], v25 offset:34816
  buffer_load_dwordx4 v38, s[16:19], s50 offen offset:2048 nt lds
  v_mfma_f32_16x16x32_bf16 v[148:151], a[88:91], a[148:151], v[148:151]
  ds_read_b64_tr_b16 a[126:127], v25 offset:35840
  v_mfma_f32_16x16x32_bf16 v[152:155], a[92:95], a[144:147], v[152:155]
  ds_read_b64_tr_b16 a[128:129], v26 offset:34816
  v_mfma_f32_16x16x32_bf16 v[156:159], a[92:95], a[148:151], v[156:159]
  ds_read_b64_tr_b16 a[130:131], v26 offset:35840
  v_mfma_f32_16x16x32_bf16 v[160:163], a[96:99], a[144:147], v[160:163]
  ds_read_b64_tr_b16 a[132:133], v27 offset:34816
  buffer_load_dwordx4 v39, s[16:19], s50 offen offset:3072 nt lds
  v_mfma_f32_16x16x32_bf16 v[164:167], a[96:99], a[148:151], v[164:167]
  ds_read_b64_tr_b16 a[134:135], v27 offset:35840
  v_mfma_f32_16x16x32_bf16 v[168:171], a[100:103], a[144:147], v[168:171]
  ds_read_b64_tr_b16 a[136:137], v28 offset:34816
  v_mfma_f32_16x16x32_bf16 v[172:175], a[100:103], a[148:151], v[172:175]
  ds_read_b64_tr_b16 a[138:139], v28 offset:35840
  s_add_u32 m0, s38, 16384
  s_add_u32 s50, s37, 16384
  v_mfma_f32_16x16x32_bf16 v[176:179], a[104:107], a[144:147], v[176:179]
  ds_read_b64_tr_b16 a[140:141], v29 offset:34816
  buffer_load_dwordx4 v34, s[12:15], s50 offen offset:0 nt lds
  v_mfma_f32_16x16x32_bf16 v[180:183], a[104:107], a[148:151], v[180:183]
  ds_read_b64_tr_b16 a[142:143], v29 offset:35840
  v_mfma_f32_16x16x32_bf16 v[184:187], a[108:111], a[144:147], v[184:187]
  v_mfma_f32_16x16x32_bf16 v[188:191], a[108:111], a[148:151], v[188:191]
  buffer_load_dwordx4 v35, s[12:15], s50 offen offset:1024 nt lds
  s_waitcnt lgkmcnt(0)
  s_barrier
  v_mfma_f32_16x16x32_bf16 v[128:131], a[112:115], a[156:159], v[128:131]
  v_mfma_f32_16x16x32_bf16 v[132:135], a[112:115], a[160:163], v[132:135]
  v_mfma_f32_16x16x32_bf16 v[192:195], a[112:115], a[164:167], v[192:195]
  buffer_load_dwordx4 v36, s[12:15], s50 offen offset:2048 nt lds
  v_mfma_f32_16x16x32_bf16 v[136:139], a[116:119], a[156:159], v[136:139]
  v_mfma_f32_16x16x32_bf16 v[140:143], a[116:119], a[160:163], v[140:143]
  v_mfma_f32_16x16x32_bf16 v[196:199], a[116:119], a[164:167], v[196:199]
  v_mfma_f32_16x16x32_bf16 v[144:147], a[120:123], a[156:159], v[144:147]
  buffer_load_dwordx4 v37, s[12:15], s50 offen offset:3072 nt lds
  v_mfma_f32_16x16x32_bf16 v[148:151], a[120:123], a[160:163], v[148:151]
  v_mfma_f32_16x16x32_bf16 v[152:155], a[124:127], a[156:159], v[152:155]
  v_mfma_f32_16x16x32_bf16 v[156:159], a[124:127], a[160:163], v[156:159]
  s_add_u32 m0, s38, 65536
  s_add_u32 s50, s37, 16384
  v_mfma_f32_16x16x32_bf16 v[160:163], a[128:131], a[156:159], v[160:163]
  buffer_load_dwordx4 v38, s[16:19], s50 offen offset:0 nt lds
  v_mfma_f32_16x16x32_bf16 v[164:167], a[128:131], a[160:163], v[164:167]
  v_mfma_f32_16x16x32_bf16 v[168:171], a[132:135], a[156:159], v[168:171]
  v_mfma_f32_16x16x32_bf16 v[172:175], a[132:135], a[160:163], v[172:175]
  v_mfma_f32_16x16x32_bf16 v[176:179], a[136:139], a[156:159], v[176:179]
  buffer_load_dwordx4 v39, s[16:19], s50 offen offset:1024 nt lds
  v_mfma_f32_16x16x32_bf16 v[180:183], a[136:139], a[160:163], v[180:183]
  v_mfma_f32_16x16x32_bf16 v[184:187], a[140:143], a[156:159], v[184:187]
  v_mfma_f32_16x16x32_bf16 v[188:191], a[140:143], a[160:163], v[188:191]
  buffer_load_dwordx4 v38, s[16:19], s50 offen offset:2048 nt lds
  s_branch K1_QX
K1_QT_ST:
  s_waitcnt vmcnt(5) lgkmcnt(0)
  s_barrier
  v_mfma_f32_16x16x32_bf16 v[128:131], a[112:115], a[156:159], v[128:131]
  ds_read_b128 a[144:147], v32 offset:17408
  ds_read_b128 a[148:151], v32 offset:18432
  v_mfma_f32_16x16x32_bf16 v[132:135], a[112:115], a[160:163], v[132:135]
  ds_read_b128 a[152:155], v33 offset:17408
  ds_read_b64_tr_b16 a[80:81], v22 offset:17408
  v_mfma_f32_16x16x32_bf16 v[192:195], a[112:115], a[164:167], v[192:195]
  ds_read_b64_tr_b16 a[82:83], v22 offset:18432
  ds_read_b64_tr_b16 a[84:85], v23 offset:17408
  v_mfma_f32_16x16x32_bf16 v[136:139], a[116:119], a[156:159], v[136:139]
  ds_read_b64_tr_b16 a[86:87], v23 offset:18432
  buffer_store_dwordx4 v[80:83], v16, s[20:23], s64 offen offset:0 sc1
  v_mfma_f32_16x16x32_bf16 v[140:143], a[116:119], a[160:163], v[140:143]
  ds_read_b64_tr_b16 a[88:89], v24 offset:17408
  v_mfma_f32_16x16x32_bf16 v[196:199], a[116:119], a[164:167], v[196:199]
  ds_read_b64_tr_b16 a[90:91], v24 offset:18432
  v_mfma_f32_16x16x32_bf16 v[144:147], a[120:123], a[156:159], v[144:147]
  ds_read_b64_tr_b16 a[92:93], v25 offset:17408
  v_mfma_f32_16x16x32_bf16 v[148:151], a[120:123], a[160:163], v[148:151]
  ds_read_b64_tr_b16 a[94:95], v25 offset:18432
  v_mfma_f32_16x16x32_bf16 v[152:155], a[124:127], a[156:159], v[152:155]
  ds_read_b64_tr_b16 a[96:97], v26 offset:17408
  v_mfma_f32_16x16x32_bf16 v[156:159], a[124:127], a[160:163], v[156:159]
  ds_read_b64_tr_b16 a[98:99], v26 offset:18432
  buffer_store_dwordx4 v[84:87], v16, s[20:23], s64 offen offset:1024 sc1
  v_mfma_f32_16x16x32_bf16 v[160:163], a[128:131], a[156:159], v[160:163]
  ds_read_b64_tr_b16 a[100:101], v27 offset:17408
  v_mfma_f32_16x16x32_bf16 v[164:167], a[128:131], a[160:163], v[164:167]
  ds_read_b64_tr_b16 a[102:103], v27 offset:18432
  v_mfma_f32_16x16x32_bf16 v[168:171], a[132:135], a[156:159], v[168:171]
  ds_read_b64_tr_b16 a[104:105], v28 offset:17408
  v_mfma_f32_16x16x32_bf16 v[172:175], a[132:135], a[160:163], v[172:175]
  ds_read_b64_tr_b16 a[106:107], v28 offset:18432
  v_mfma_f32_16x16x32_bf16 v[176:179], a[136:139], a[156:159], v[176:179]
  ds_read_b64_tr_b16 a[108:109], v29 offset:17408
  v_mfma_f32_16x16x32_bf16 v[180:183], a[136:139], a[160:163], v[180:183]
  ds_read_b64_tr_b16 a[110:111], v29 offset:18432
  buffer_store_dwordx4 v[88:91], v16, s[20:23], s64 offen offset:2048 sc1
  v_mfma_f32_16x16x32_bf16 v[184:187], a[140:143], a[156:159], v[184:187]
  v_mfma_f32_16x16x32_bf16 v[188:191], a[140:143], a[160:163], v[188:191]
  s_waitcnt vmcnt(3) lgkmcnt(0)
  s_barrier
  v_mfma_f32_16x16x32_bf16 v[128:131], a[80:83], a[144:147], v[128:131]
  ds_read_b128 a[156:159], v32 offset:34816
  ds_read_b128 a[160:163], v32 offset:35840
  v_mfma_f32_16x16x32_bf16 v[132:135], a[80:83], a[148:151], v[132:135]
  ds_read_b128 a[164:167], v33 offset:34816
  ds_read_b64_tr_b16 a[112:113], v22 offset:34816
  v_mfma_f32_16x16x32_bf16 v[192:195], a[80:83], a[152:155], v[192:195]
  ds_read_b64_tr_b16 a[114:115], v22 offset:35840
  ds_read_b64_tr_b16 a[116:117], v23 offset:34816
  v_mfma_f32_16x16x32_bf16 v[136:139], a[84:87], a[144:147], v[136:139]
  ds_read_b64_tr_b16 a[118:119], v23 offset:35840
  buffer_store_dwordx4 v[92:95], v16, s[20:23], s64 offen offset:3072 sc1
  v_mfma_f32_16x16x32_bf16 v[140:143], a[84:87], a[148:151], v[140:143]
  ds_read_b64_tr_b16 a[120:121], v24 offset:34816
  v_mfma_f32_16x16x32_bf16 v[196:199], a[84:87], a[152:155], v[196:199]
  ds_read_b64_tr_b16 a[122:123], v24 offset:35840
  v_mfma_f32_16x16x32_bf16 v[144:147], a[88:91], a[144:147], v[144:147]
  ds_read_b64_tr_b16 a[124:125], v25 offset:34816
  v_mfma_f32_16x16x32_bf16 v[148:151], a[88:91], a[148:151], v[148:151]
  ds_read_b64_tr_b16 a[126:127], v25 offset:35840
  v_mfma_f32_16x16x32_bf16 v[152:155], a[92:95], a[144:147], v[152:155]
  ds_read_b64_tr_b16 a[128:129], v26 offset:34816
  v_mfma_f32_16x16x32_bf16 v[156:159], a[92:95], a[148:151], v[156:159]
  ds_read_b64_tr_b16 a[130:131], v26 offset:35840
  buffer_store_dwordx4 v[96:99], v16, s[20:23], s65 offen offset:0 sc1
  v_mfma_f32_16x16x32_bf16 v[160:163], a[96:99], a[144:147], v[160:163]
  ds_read_b64_tr_b16 a[132:133], v27 offset:34816
  v_mfma_f32_16x16x32_bf16 v[164:167], a[96:99], a[148:151], v[164:167]
  ds_read_b64_tr_b16 a[134:135], v27 offset:35840
  v_mfma_f32_16x16x32_bf16 v[168:171], a[100:103], a[144:147], v[168:171]
  ds_read_b64_tr_b16 a[136:137], v28 offset:34816
  v_mfma_f32_16x16x32_bf16 v[172:175], a[100:103], a[148:151], v[172:175]
  ds_read_b64_tr_b16 a[138:139], v28 offset:35840
  v_mfma_f32_16x16x32_bf16 v[176:179], a[104:107], a[144:147], v[176:179]
  ds_read_b64_tr_b16 a[140:141], v29 offset:34816
  v_mfma_f32_16x16x32_bf16 v[180:183], a[104:107], a[148:151], v[180:183]
  ds_read_b64_tr_b16 a[142:143], v29 offset:35840
  buffer_store_dwordx4 v[100:103], v16, s[20:23], s65 offen offset:1024 sc1
  v_mfma_f32_16x16x32_bf16 v[184:187], a[108:111], a[144:147], v[184:187]
  v_mfma_f32_16x16x32_bf16 v[188:191], a[108:111], a[148:151], v[188:191]
  s_waitcnt lgkmcnt(0)
  s_barrier
  v_mfma_f32_16x16x32_bf16 v[128:131], a[112:115], a[156:159], v[128:131]
  v_mfma_f32_16x16x32_bf16 v[132:135], a[112:115], a[160:163], v[132:135]
  v_mfma_f32_16x16x32_bf16 v[192:195], a[112:115], a[164:167], v[192:195]
  buffer_store_dwordx4 v[104:107], v16, s[20:23], s65 offen offset:2048 sc1
  v_mfma_f32_16x16x32_bf16 v[136:139], a[116:119], a[156:159], v[136:139]
  v_mfma_f32_16x16x32_bf16 v[140:143], a[116:119], a[160:163], v[140:143]
  v_mfma_f32_16x16x32_bf16 v[196:199], a[116:119], a[164:167], v[196:199]
  v_mfma_f32_16x16x32_bf16 v[144:147], a[120:123], a[156:159], v[144:147]
  v_mfma_f32_16x16x32_bf16 v[148:151], a[120:123], a[160:163], v[148:151]
  buffer_store_dwordx4 v[108:111], v16, s[20:23], s65 offen offset:3072 sc1
  v_mfma_f32_16x16x32_bf16 v[152:155], a[124:127], a[156:159], v[152:155]
  v_mfma_f32_16x16x32_bf16 v[156:159], a[124:127], a[160:163], v[156:159]
  v_mfma_f32_16x16x32_bf16 v[160:163], a[128:131], a[156:159], v[160:163]
  v_mfma_f32_16x16x32_bf16 v[164:167], a[128:131], a[160:163], v[164:167]
  v_mfma_f32_16x16x32_bf16 v[168:171], a[132:135], a[156:159], v[168:171]
  buffer_store_dwordx2 v[112:113], v17, s[20:23], s66 offen offset:0 sc1
  v_mfma_f32_16x16x32_bf16 v[172:175], a[132:135], a[160:163], v[172:175]
  v_mfma_f32_16x16x32_bf16 v[176:179], a[136:139], a[156:159], v[176:179]
  v_mfma_f32_16x16x32_bf16 v[180:183], a[136:139], a[160:163], v[180:183]
  v_mfma_f32_16x16x32_bf16 v[184:187], a[140:143], a[156:159], v[184:187]
  v_mfma_f32_16x16x32_bf16 v[188:191], a[140:143], a[160:163], v[188:191]
  buffer_store_dwordx2 v[114:115], v17, s[20:23], s66 offen offset:1024 sc1
  s_branch K1_QX
K1_QT_NEXT:
  s_lshl_b32 s33, s55, 8
  s_add_u32 s63, s33, 31744
  s_mov_b32 s32, 0
  s_mov_b32 s58, 17408
  s_mov_b32 s59, 34816
  s_waitcnt vmcnt(5) lgkmcnt(0)
  s_barrier
  v_mfma_f32_16x16x32_bf16 v[128:131], a[112:115], a[156:159], v[128:131]
  ds_read_b128 a[144:147], v32 offset:17408
  ds_read_b128 a[148:151], v32 offset:18432
  v_mfma_f32_16x16x32_bf16 v[132:135], a[112:115], a[160:163], v[132:135]
  ds_read_b128 a[152:155], v33 offset:17408
  ds_read_b64_tr_b16 a[80:81], v22 offset:17408
  s_add_u32 m0, s56, 107520
  v_mfma_f32_16x16x32_bf16 v[192:195], a[112:115], a[164:167], v[192:195]
  ds_read_b64_tr_b16 a[82:83], v22 offset:18432
  ds_read_b64_tr_b16 a[84:85], v23 offset:17408
  buffer_load_dwordx4 v31, s[8:11], s33 offen lds
  v_mfma_f32_16x16x32_bf16 v[136:139], a[116:119], a[156:159], v[136:139]
  ds_read_b64_tr_b16 a[86:87], v23 offset:18432
  v_mfma_f32_16x16x32_bf16 v[140:143], a[116:119], a[160:163], v[140:143]
  ds_read_b64_tr_b16 a[88:89], v24 offset:17408
  v_mfma_f32_16x16x32_bf16 v[196:199], a[116:119], a[164:167], v[196:199]
  ds_read_b64_tr_b16 a[90:91], v24 offset:18432
  v_mfma_f32_16x16x32_bf16 v[144:147], a[120:123], a[156:159], v[144:147]
  ds_read_b64_tr_b16 a[92:93], v25 offset:17408
  buffer_load_dwordx4 v31, s[8:11], s63 offen offset:1024 lds
  s_add_u32 m0, s57, 98304
  s_add_u32 s33, s33, 262144
  s_add_u32 s63, s63, 262144
  v_mfma_f32_16x16x32_bf16 v[148:151], a[120:123], a[160:163], v[148:151]
  ds_read_b64_tr_b16 a[94:95], v25 offset:18432
  v_mfma_f32_16x16x32_bf16 v[152:155], a[124:127], a[156:159], v[152:155]
  ds_read_b64_tr_b16 a[96:97], v26 offset:17408
  v_mfma_f32_16x16x32_bf16 v[156:159], a[124:127], a[160:163], v[156:159]
  ds_read_b64_tr_b16 a[98:99], v26 offset:18432
  v_mfma_f32_16x16x32_bf16 v[160:163], a[128:131], a[156:159], v[160:163]
  ds_read_b64_tr_b16 a[100:101], v27 offset:17408
  buffer_load_dwordx4 v30, s[4:7], s32 offen offset:0 lds
  s_add_u32 s32, s32, 64
  v_mfma_f32_16x16x32_bf16 v[164:167], a[128:131], a[160:163], v[164:167]
  ds_read_b64_tr_b16 a[102:103], v27 offset:18432
  v_mfma_f32_16x16x32_bf16 v[168:171], a[132:135], a[156:159], v[168:171]
  ds_read_b64_tr_b16 a[104:105], v28 offset:17408
  v_mfma_f32_16x16x32_bf16 v[172:175], a[132:135], a[160:163], v[172:175]
  ds_read_b64_tr_b16 a[106:107], v28 offset:18432
  v_mfma_f32_16x16x32_bf16 v[176:179], a[136:139], a[156:159], v[176:179]
  ds_read_b64_tr_b16 a[108:109], v29 offset:17408
  buffer_load_dwordx4 v30, s[4:7], s58 offen offset:1024 lds
  s_add_u32 s58, s58, 64
  v_mfma_f32_16x16x32_bf16 v[180:183], a[136:139], a[160:163], v[180:183]
  ds_read_b64_tr_b16 a[110:111], v29 offset:18432
  v_mfma_f32_16x16x32_bf16 v[184:187], a[140:143], a[156:159], v[184:187]
  v_mfma_f32_16x16x32_bf16 v[188:191], a[140:143], a[160:163], v[188:191]
  s_mov_b64 exec, 0xffff
  buffer_load_dwordx4 v30, s[4:7], s59 offen offset:2048 lds
  s_mov_b64 exec, -1
  s_add_u32 s59, s59, 64
  s_waitcnt vmcnt(5) lgkmcnt(0)
  s_barrier
  v_mfma_f32_16x16x32_bf16 v[128:131], a[80:83], a[144:147], v[128:131]
  ds_read_b128 a[156:159], v32 offset:34816
  ds_read_b128 a[160:163], v32 offset:35840
  v_mfma_f32_16x16x32_bf16 v[132:135], a[80:83], a[148:151], v[132:135]
  ds_read_b128 a[164:167], v33 offset:34816
  ds_read_b64_tr_b16 a[112:113], v22 offset:34816
  s_add_u32 m0, s56, 124928
  v_mfma_f32_16x16x32_bf16 v[192:195], a[80:83], a[152:155], v[192:195]
  ds_read_b64_tr_b16 a[114:115], v22 offset:35840
  ds_read_b64_tr_b16 a[116:117], v23 offset:34816
  buffer_load_dwordx4 v31, s[8:11], s33 offen lds
  v_mfma_f32_16x16x32_bf16 v[136:139], a[84:87], a[144:147], v[136:139]
  ds_read_b64_tr_b16 a[118:119], v23 offset:35840
  v_mfma_f32_16x16x32_bf16 v[140:143], a[84:87], a[148:151], v[140:143]
  ds_read_b64_tr_b16 a[120:121], v24 offset:34816
  v_mfma_f32_16x16x32_bf16 v[196:199], a[84:87], a[152:155], v[196:199]
  ds_read_b64_tr_b16 a[122:123], v24 offset:35840
  v_mfma_f32_16x16x32_bf16 v[144:147], a[88:91], a[144:147], v[144:147]
  ds_read_b64_tr_b16 a[124:125], v25 offset:34816
  buffer_load_dwordx4 v31, s[8:11], s63 offen offset:1024 lds
  s_add_u32 m0, s57, 115712
  s_add_u32 s33, s33, 262144
  s_add_u32 s63, s63, 262144
  v_mfma_f32_16x16x32_bf16 v[148:151], a[88:91], a[148:151], v[148:151]
  ds_read_b64_tr_b16 a[126:127], v25 offset:35840
  v_mfma_f32_16x16x32_bf16 v[152:155], a[92:95], a[144:147], v[152:155]
  ds_read_b64_tr_b16 a[128:129], v26 offset:34816
  v_mfma_f32_16x16x32_bf16 v[156:159], a[92:95], a[148:151], v[156:159]
  ds_read_b64_tr_b16 a[130:131], v26 offset:35840
  v_mfma_f32_16x16x32_bf16 v[160:163], a[96:99], a[144:147], v[160:163]
  ds_read_b64_tr_b16 a[132:133], v27 offset:34816
  buffer_load_dwordx4 v30, s[4:7], s32 offen offset:0 lds
  s_add_u32 s32, s32, 64
  v_mfma_f32_16x16x32_bf16 v[164:167], a[96:99], a[148:151], v[164:167]
  ds_read_b64_tr_b16 a[134:135], v27 offset:35840
  v_mfma_f32_16x16x32_bf16 v[168:171], a[100:103], a[144:147], v[168:171]
  ds_read_b64_tr_b16 a[136:137], v28 offset:34816
  v_mfma_f32_16x16x32_bf16 v[172:175], a[100:103], a[148:151], v[172:175]
  ds_read_b64_tr_b16 a[138:139], v28 offset:35840
  v_mfma_f32_16x16x32_bf16 v[176:179], a[104:107], a[144:147], v[176:179]
  ds_read_b64_tr_b16 a[140:141], v29 offset:34816
  buffer_load_dwordx4 v30, s[4:7], s58 offen offset:1024 lds
  s_add_u32 s58, s58, 64
  v_mfma_f32_16x16x32_bf16 v[180:183], a[104:107], a[148:151], v[180:183]
  ds_read_b64_tr_b16 a[142:143], v29 offset:35840
  v_mfma_f32_16x16x32_bf16 v[184:187], a[108:111], a[144:147], v[184:187]
  v_mfma_f32_16x16x32_bf16 v[188:191], a[108:111], a[148:151], v[188:191]
  s_mov_b64 exec, 0xffff
  buffer_load_dwordx4 v30, s[4:7], s59 offen offset:2048 lds
  s_mov_b64 exec, -1
  s_add_u32 s59, s59, 64
  s_waitcnt lgkmcnt(0)
  s_barrier
  v_mfma_f32_16x16x32_bf16 v[128:131], a[112:115], a[156:159], v[128:131]
  v_mfma_f32_16x16x32_bf16 v[132:135], a[112:115], a[160:163], v[132:135]
  s_add_u32 m0, s56, 142336
  v_mfma_f32_16x16x32_bf16 v[192:195], a[112:115], a[164:167], v[192:195]
  buffer_load_dwordx4 v31, s[8:11], s33 offen lds
  v_mfma_f32_16x16x32_bf16 v[136:139], a[116:119], a[156:159], v[136:139]
  v_mfma_f32_16x16x32_bf16 v[140:143], a[116:119], a[160:163], v[140:143]
  v_mfma_f32_16x16x32_bf16 v[196:199], a[116:119], a[164:167], v[196:199]
  v_mfma_f32_16x16x32_bf16 v[144:147], a[120:123], a[156:159], v[144:147]
  buffer_load_dwordx4 v31, s[8:11], s63 offen offset:1024 lds
  s_add_u32 m0, s57, 133120
  s_add_u32 s33, s33, 262144
  s_add_u32 s63, s63, 262144
  v_mfma_f32_16x16x32_bf16 v[148:151], a[120:123], a[160:163], v[148:151]
  v_mfma_f32_16x16x32_bf16 v[152:155], a[124:127], a[156:159], v[152:155]
  v_mfma_f32_16x16x32_bf16 v[156:159], a[124:127], a[160:163], v[156:159]
  v_mfma_f32_16x16x32_bf16 v[160:163], a[128:131], a[156:159], v[160:163]
  buffer_load_dwordx4 v30, s[4:7], s32 offen offset:0 lds
  s_add_u32 s32, s32, 64
  v_mfma_f32_16x16x32_bf16 v[164:167], a[128:131], a[160:163], v[164:167]
  v_mfma_f32_16x16x32_bf16 v[168:171], a[132:135], a[156:159], v[168:171]
  v_mfma_f32_16x16x32_bf16 v[172:175], a[132:135], a[160:163], v[172:175]
  v_mfma_f32_16x16x32_bf16 v[176:179], a[136:139], a[156:159], v[176:179]
  buffer_load_dwordx4 v30, s[4:7], s58 offen offset:1024 lds
  s_add_u32 s58, s58, 64
  v_mfma_f32_16x16x32_bf16 v[180:183], a[136:139], a[160:163], v[180:183]
  v_mfma_f32_16x16x32_bf16 v[184:187], a[140:143], a[156:159], v[184:187]
  v_mfma_f32_16x16x32_bf16 v[188:191], a[140:143], a[160:163], v[188:191]
  s_mov_b64 exec, 0xffff
  buffer_load_dwordx4 v30, s[4:7], s59 offen offset:2048 lds
  s_mov_b64 exec, -1
  s_add_u32 s59, s59, 64
K1_QX:
  s_nop 15
  s_nop 3
  v_and_b32 v1, 15, v0
  v_lshrrev_b32 v2, 4, v0
  v_lshlrev_b32 v8, 8, v1
  v_lshrrev_b32 v9, 1, v2
  v_xor_b32 v9, v9, v1
  v_lshl_add_u32 v8, v9, 4, v8
  v_and_b32 v9, 1, v2
  v_lshl_add_u32 v8, v9, 3, v8
  s_lshl_b32 s47, s3, 6
  v_xor_b32 v8, s47, v8
  v_add_u32 v8, s62, v8
  v_xor_b32 v9, 32, v8
  v_mul_f32 v192, s39, v192
  v_mul_f32 v193, s39, v193
  v_mul_f32 v194, s39, v194
  v_mul_f32 v195, s39, v195
  v_mul_f32 v196, s39, v196
  v_mul_f32 v197, s39, v197
  v_mul_f32 v198, s39, v198
  v_mul_f32 v199, s39, v199
  v_cvt_pk_bf16_f32 v224, v192, v193
  v_cvt_pk_bf16_f32 v225, v194, v195
  v_cvt_pk_bf16_f32 v226, v196, v197
  v_cvt_pk_bf16_f32 v227, v198, v199
  ds_write_b64 v8, v[224:225]
  ds_write_b64 v9, v[226:227]
  v_mul_f32 v128, s39, v128
  v_mul_f32 v129, s39, v129
  v_mul_f32 v130, s39, v130
  v_mul_f32 v131, s39, v131
  v_mul_f32 v132, s39, v132
  v_mul_f32 v133, s39, v133
  v_mul_f32 v134, s39, v134
  v_mul_f32 v135, s39, v135
  v_cvt_pk_bf16_f32 v192, v128, v129
  v_cvt_pk_bf16_f32 v193, v130, v131
  v_cvt_pk_bf16_f32 v194, v132, v133
  v_cvt_pk_bf16_f32 v195, v134, v135
  v_mul_f32 v136, s39, v136
  v_mul_f32 v137, s39, v137
  v_mul_f32 v138, s39, v138
  v_mul_f32 v139, s39, v139
  v_mul_f32 v140, s39, v140
  v_mul_f32 v141, s39, v141
  v_mul_f32 v142, s39, v142
  v_mul_f32 v143, s39, v143
  v_cvt_pk_bf16_f32 v196, v136, v137
  v_cvt_pk_bf16_f32 v197, v138, v139
  v_cvt_pk_bf16_f32 v198, v140, v141
  v_cvt_pk_bf16_f32 v199, v142, v143
  v_permlane16_swap_b32 v192, v194
  v_permlane16_swap_b32 v193, v195
  v_mul_f32 v144, s39, v144
  v_mul_f32 v145, s39, v145
  v_mul_f32 v146, s39, v146
  v_mul_f32 v147, s39, v147
  v_mul_f32 v148, s39, v148
  v_mul_f32 v149, s39, v149
  v_mul_f32 v150, s39, v150
  v_mul_f32 v151, s39, v151
  v_cvt_pk_bf16_f32 v200, v144, v145
  v_cvt_pk_bf16_f32 v201, v146, v147
  v_cvt_pk_bf16_f32 v202, v148, v149
  v_cvt_pk_bf16_f32 v203, v150, v151
  v_permlane16_swap_b32 v196, v198
  v_permlane16_swap_b32 v197, v199
  v_mul_f32 v152, s39, v152
  v_mul_f32 v153, s39, v153
  v_mul_f32 v154, s39, v154
  v_mul_f32 v155, s39, v155
  v_mul_f32 v156, s39, v156
  v_mul_f32 v157, s39, v157
  v_mul_f32 v158, s39, v158
  v_mul_f32 v159, s39, v159
  v_cvt_pk_bf16_f32 v204, v152, v153
  v_cvt_pk_bf16_f32 v205, v154, v155
  v_cvt_pk_bf16_f32 v206, v156, v157
  v_cvt_pk_bf16_f32 v207, v158, v159
  v_permlane16_swap_b32 v200, v202
  v_permlane16_swap_b32 v201, v203
  v_mul_f32 v160, s39, v160
  v_mul_f32 v161, s39, v161
  v_mul_f32 v162, s39, v162
  v_mul_f32 v163, s39, v163
  v_mul_f32 v164, s39, v164
  v_mul_f32 v165, s39, v165
  v_mul_f32 v166, s39, v166
  v_mul_f32 v167, s39, v167
  v_cvt_pk_bf16_f32 v208, v160, v161
  v_cvt_pk_bf16_f32 v209, v162, v163
  v_cvt_pk_bf16_f32 v210, v164, v165
  v_cvt_pk_bf16_f32 v211, v166, v167
  v_permlane16_swap_b32 v204, v206
  v_permlane16_swap_b32 v205, v207
  v_mul_f32 v168, s39, v168
  v_mul_f32 v169, s39, v169
  v_mul_f32 v170, s39, v170
  v_mul_f32 v171, s39, v171
  v_mul_f32 v172, s39, v172
  v_mul_f32 v173, s39, v173
  v_mul_f32 v174, s39, v174
  v_mul_f32 v175, s39, v175
  v_cvt_pk_bf16_f32 v212, v168, v169
  v_cvt_pk_bf16_f32 v213, v170, v171
  v_cvt_pk_bf16_f32 v214, v172, v173
  v_cvt_pk_bf16_f32 v215, v174, v175
  v_permlane16_swap_b32 v208, v210
  v_permlane16_swap_b32 v209, v211
  v_mul_f32 v176, s39, v176
  v_mul_f32 v177, s39, v177
  v_mul_f32 v178, s39, v178
  v_mul_f32 v179, s39, v179
  v_mul_f32 v180, s39, v180
  v_mul_f32 v181, s39, v181
  v_mul_f32 v182, s39, v182
  v_mul_f32 v183, s39, v183
  v_cvt_pk_bf16_f32 v216, v176, v177
  v_cvt_pk_bf16_f32 v217, v178, v179
  v_cvt_pk_bf16_f32 v218, v180, v181
  v_cvt_pk_bf16_f32 v219, v182, v183
  v_permlane16_swap_b32 v212, v214
  v_permlane16_swap_b32 v213, v215
  v_mul_f32 v184, s39, v184
  v_mul_f32 v185, s39, v185
  v_mul_f32 v186, s39, v186
  v_mul_f32 v187, s39, v187
  v_mul_f32 v188, s39, v188
  v_mul_f32 v189, s39, v189
  v_mul_f32 v190, s39, v190
  v_mul_f32 v191, s39, v191
  v_cvt_pk_bf16_f32 v220, v184, v185
  v_cvt_pk_bf16_f32 v221, v186, v187
  v_cvt_pk_bf16_f32 v222, v188, v189
  v_cvt_pk_bf16_f32 v223, v190, v191
  v_permlane16_swap_b32 v216, v218
  v_permlane16_swap_b32 v217, v219
  s_nop 1
  v_permlane16_swap_b32 v220, v222
  v_permlane16_swap_b32 v221, v223
  s_nop 1
  s_bitcmp1_b32 s95, 2
  s_cbranch_scc1 K1_SLOW_ATT
  s_cmp_eq_u32 s61, 0
  s_cbranch_scc1 K1_TPRE
  s_cmp_eq_u32 s61, 2
  s_cbranch_scc1 K1_PARK1
  v_accvgpr_write_b32 a0, v192
  v_accvgpr_write_b32 a1, v193
  v_accvgpr_write_b32 a2, v194
  v_accvgpr_write_b32 a3, v195
  v_accvgpr_write_b32 a4, v196
  v_accvgpr_write_b32 a5, v197
  v_accvgpr_write_b32 a6, v198
  v_accvgpr_write_b32 a7, v199
  v_accvgpr_write_b32 a8, v200
  v_accvgpr_write_b32 a9, v201
  v_accvgpr_write_b32 a10, v202
  v_accvgpr_write_b32 a11, v203
  v_accvgpr_write_b32 a12, v204
  v_accvgpr_write_b32 a13, v205
  v_accvgpr_write_b32 a14, v206
  v_accvgpr_write_b32 a15, v207
  v_accvgpr_write_b32 a16, v208
  v_accvgpr_write_b32 a17, v209
  v_accvgpr_write_b32 a18, v210
  v_accvgpr_write_b32 a19, v211
  v_accvgpr_write_b32 a20, v212
  v_accvgpr_write_b32 a21, v213
  v_accvgpr_write_b32 a22, v214
  v_accvgpr_write_b32 a23, v215
  v_accvgpr_write_b32 a24, v216
  v_accvgpr_write_b32 a25, v217
  v_accvgpr_write_b32 a26, v218
  v_accvgpr_write_b32 a27, v219
  v_accvgpr_write_b32 a28, v220
  v_accvgpr_write_b32 a29, v221
  v_accvgpr_write_b32 a30, v222
  v_accvgpr_write_b32 a31, v223
  s_mov_b32 s61, 2
  s_mov_b32 s67, 0
  s_add_u32 s62, s62, 4096
  s_branch K1_Q
K1_PARK1:
  v_accvgpr_write_b32 a32, v192
  v_accvgpr_write_b32 a33, v193
  v_accvgpr_write_b32 a34, v194
  v_accvgpr_write_b32 a35, v195
  v_accvgpr_write_b32 a36, v196
  v_accvgpr_write_b32 a37, v197
  v_accvgpr_write_b32 a38, v198
  v_accvgpr_write_b32 a39, v199
  v_accvgpr_write_b32 a40, v200
  v_accvgpr_write_b32 a41, v201
  v_accvgpr_write_b32 a42, v202
  v_accvgpr_write_b32 a43, v203
  v_accvgpr_write_b32 a44, v204
  v_accvgpr_write_b32 a45, v205
  v_accvgpr_write_b32 a46, v206
  v_accvgpr_write_b32 a47, v207
  v_accvgpr_write_b32 a48, v208
  v_accvgpr_write_b32 a49, v209
  v_accvgpr_write_b32 a50, v210
  v_accvgpr_write_b32 a51, v211
  v_accvgpr_write_b32 a52, v212
  v_accvgpr_write_b32 a53, v213
  v_accvgpr_write_b32 a54, v214
  v_accvgpr_write_b32 a55, v215
  v_accvgpr_write_b32 a56, v216
  v_accvgpr_write_b32 a57, v217
  v_accvgpr_write_b32 a58, v218
  v_accvgpr_write_b32 a59, v219
  v_accvgpr_write_b32 a60, v220
  v_accvgpr_write_b32 a61, v221
  v_accvgpr_write_b32 a62, v222
  v_accvgpr_write_b32 a63, v223
  v_accvgpr_read_b32 v192, a0
  v_accvgpr_read_b32 v193, a1
  v_accvgpr_read_b32 v194, a2
  v_accvgpr_read_b32 v195, a3
  v_accvgpr_read_b32 v196, a4
  v_accvgpr_read_b32 v197, a5
  v_accvgpr_read_b32 v198, a6
  v_accvgpr_read_b32 v199, a7
  v_accvgpr_read_b32 v200, a8
  v_accvgpr_read_b32 v201, a9
  v_accvgpr_read_b32 v202, a10
  v_accvgpr_read_b32 v203, a11
  v_accvgpr_read_b32 v204, a12
  v_accvgpr_read_b32 v205, a13
  v_accvgpr_read_b32 v206, a14
  v_accvgpr_read_b32 v207, a15
  v_accvgpr_read_b32 v208, a16
  v_accvgpr_read_b32 v209, a17
  v_accvgpr_read_b32 v210, a18
  v_accvgpr_read_b32 v211, a19
  v_accvgpr_read_b32 v212, a20
  v_accvgpr_read_b32 v213, a21
  v_accvgpr_read_b32 v214, a22
  v_accvgpr_read_b32 v215, a23
  v_accvgpr_read_b32 v216, a24
  v_accvgpr_read_b32 v217, a25
  v_accvgpr_read_b32 v218, a26
  v_accvgpr_read_b32 v219, a27
  v_accvgpr_read_b32 v220, a28
  v_accvgpr_read_b32 v221, a29
  v_accvgpr_read_b32 v222, a30
  v_accvgpr_read_b32 v223, a31
  s_sub_u32 s62, s62, 4096
  s_mov_b32 s61, 3
K1_TPRE:
  s_waitcnt lgkmcnt(0)
  s_barrier
  v_and_b32 v1, 15, v0
  v_lshrrev_b32 v2, 4, v0
  v_lshlrev_b32 v8, 8, v1
  v_xor_b32 v9, v2, v1
  v_lshl_add_u32 v8, v9, 4, v8
  v_add_u32 v8, s62, v8
  v_xor_b32 v9, 0, v8
  ds_read_b128 a[64:67], v9
  v_xor_b32 v9, 64, v8
  ds_read_b128 a[68:71], v9
  v_xor_b32 v9, 128, v8
  ds_read_b128 a[72:75], v9
  v_xor_b32 v9, 192, v8
  ds_read_b128 a[76:79], v9
  s_cmp_eq_u32 s30, 0
  s_cbranch_scc0 K1_TPRE_NN
  s_cmp_eq_u32 s3, 0
  s_cbranch_scc0 OP_NI
  v_mov_b32 v246, 0
  global_load_dword v246, v246, s[100:101]
OP_NI:
K1_TPRE_NN:
  s_cmp_eq_u32 s30, 1
  s_cbranch_scc1 K1_TPRE_NF
  s_and_b32 s40, s30, s60
  s_cbranch_scc1 K1_TPRE_NF
  buffer_load_dwordx4 v39, s[16:19], s50 offen offset:3072 nt lds
  s_add_u32 m0, s38, 32768
  s_add_u32 s50, s37, 32768
  s_nop 0
  buffer_load_dwordx4 v34, s[12:15], s50 offen offset:0 nt lds
  buffer_load_dwordx4 v35, s[12:15], s50 offen offset:1024 nt lds
  buffer_load_dwordx4 v36, s[12:15], s50 offen offset:2048 nt lds
  buffer_load_dwordx4 v37, s[12:15], s50 offen offset:3072 nt lds
  s_cmp_eq_u32 s30, 1
  s_cbranch_scc0 K1_TPRE_NF
  buffer_store_dwordx4 v[80:83], v16, s[20:23], s64 offen offset:0 sc1
  buffer_store_dwordx4 v[84:87], v16, s[20:23], s64 offen offset:1024 sc1
  buffer_store_dwordx4 v[88:91], v16, s[20:23], s64 offen offset:2048 sc1
  buffer_store_dwordx4 v[92:95], v16, s[20:23], s64 offen offset:3072 sc1
  buffer_store_dwordx4 v[96:99], v16, s[20:23], s65 offen offset:0 sc1
  buffer_store_dwordx4 v[100:103], v16, s[20:23], s65 offen offset:1024 sc1
  buffer_store_dwordx4 v[104:107], v16, s[20:23], s65 offen offset:2048 sc1
  buffer_store_dwordx4 v[108:111], v16, s[20:23], s65 offen offset:3072 sc1
  buffer_store_dwordx2 v[112:113], v17, s[20:23], s66 offen offset:0 sc1
  buffer_store_dwordx2 v[114:115], v17, s[20:23], s66 offen offset:1024 sc1
K1_TPRE_NF:
  v_mfma_f32_32x32x16_bf16 v[128:143], v[76:79], v[76:79], 0
  v_mfma_f32_32x32x16_bf16 v[144:159], v[76:79], v[76:79], 0
  v_mfma_f32_32x32x16_bf16 v[160:175], v[76:79], v[76:79], 0
  v_mfma_f32_32x32x16_bf16 v[176:191], v[76:79], v[76:79], 0
  v_mfma_f32_16x16x32_bf16 a[176:179], v[76:79], v[76:79], 0
  v_mov_b32 v88, 0
  v_mfma_f32_16x16x32_bf16 a[180:183], v[76:79], v[76:79], 0
  v_mov_b32 v89, 0
  v_mfma_f32_16x16x32_bf16 a[184:187], v[76:79], v[76:79], 0
  v_mov_b32 v90, 0
  v_mfma_f32_16x16x32_bf16 a[188:191], v[76:79], v[76:79], 0
  v_mov_b32 v91, 0
  v_mfma_f32_16x16x32_bf16 a[192:195], v[76:79], v[76:79], 0
  v_mov_b32 v92, 0
  v_mfma_f32_16x16x32_bf16 a[196:199], v[76:79], v[76:79], 0
  v_mov_b32 v93, 0
  v_mfma_f32_16x16x32_bf16 a[200:203], v[76:79], v[76:79], 0
  v_mov_b32 v94, 0
  v_mfma_f32_16x16x32_bf16 a[204:207], v[76:79], v[76:79], 0
  v_mov_b32 v95, 0
  v_mov_b32 v64, 0
  v_mov_b32 v66, 0
K1_ATT:
  s_mov_b32 s34, 0
  s_mov_b32 s96, 0x400000
  s_cmp_eq_u32 s30, 1
  s_cbranch_scc1 K1_ATT1
  s_add_u32 s35, s37, 49152
  s_add_u32 s36, s37, 32768
  s_cmp_eq_u32 s30, 1
  s_cbranch_scc1 K1_ATT2
  s_cmp_eq_u32 s60, s60
  s_cselect_b32 s96, 1982464, s96
  s_waitcnt vmcnt(16) lgkmcnt(0)
  s_barrier
  ds_read_b128 a[80:83], v40 offset:0
  ds_read_b128 a[84:87], v41 offset:0
  ds_read_b128 a[88:91], v42 offset:0
  ds_read_b128 a[92:95], v43 offset:0
  ds_read_b128 a[96:99], v44 offset:0
  ds_read_b128 a[100:103], v45 offset:0
  ds_read_b128 a[104:107], v46 offset:0
  ds_read_b128 a[108:111], v47 offset:0
  ds_read_b128 a[112:115], v52 offset:0
  ds_read_b128 a[116:119], v53 offset:0
  ds_read_b128 a[120:123], v54 offset:0
  ds_read_b128 a[124:127], v55 offset:0
  s_waitcnt lgkmcnt(0)
  v_mfma_f32_32x32x16_bf16 v[96:111], a[80:83], v[192:195], 0
  ds_read_b128 a[80:83], v40 offset:8192
  v_mfma_f32_32x32x16_bf16 v[96:111], a[84:87], v[196:199], v[96:111]
  ds_read_b128 a[84:87], v41 offset:8192
  v_mfma_f32_32x32x16_bf16 v[96:111], a[88:91], v[200:203], v[96:111]
  ds_read_b128 a[88:91], v42 offset:8192
  v_mfma_f32_32x32x16_bf16 v[96:111], a[92:95], v[204:207], v[96:111]
  ds_read_b128 a[92:95], v43 offset:8192
  v_mfma_f32_32x32x16_bf16 v[96:111], a[96:99], v[208:211], v[96:111]
  ds_read_b128 a[96:99], v44 offset:8192
  v_mfma_f32_32x32x16_bf16 v[96:111], a[100:103], v[212:215], v[96:111]
  ds_read_b128 a[100:103], v45 offset:8192
  v_mfma_f32_32x32x16_bf16 v[96:111], a[104:107], v[216:219], v[96:111]
  ds_read_b128 a[104:107], v46 offset:8192
  v_mfma_f32_32x32x16_bf16 v[96:111], a[108:111], v[220:223], v[96:111]
  ds_read_b128 a[108:111], v47 offset:8192
  v_mfma_f32_16x16x32_bf16 v[72:75], a[112:115], a[64:67], 0
  v_mfma_f32_16x16x32_bf16 v[72:75], a[116:119], a[68:71], v[72:75]
  v_mfma_f32_16x16x32_bf16 v[72:75], a[120:123], a[72:75], v[72:75]
  v_mfma_f32_16x16x32_bf16 v[72:75], a[124:127], a[76:79], v[72:75]
  s_waitcnt vmcnt(8) lgkmcnt(0)
  s_branch K1_S0_BAR
K1_ATT2:
  s_waitcnt vmcnt(26) lgkmcnt(0)
  s_barrier
  ds_read_b128 a[80:83], v40 offset:0
  ds_read_b128 a[84:87], v41 offset:0
  ds_read_b128 a[88:91], v42 offset:0
  ds_read_b128 a[92:95], v43 offset:0
  ds_read_b128 a[96:99], v44 offset:0
  ds_read_b128 a[100:103], v45 offset:0
  ds_read_b128 a[104:107], v46 offset:0
  ds_read_b128 a[108:111], v47 offset:0
  ds_read_b128 a[112:115], v52 offset:0
  ds_read_b128 a[116:119], v53 offset:0
  ds_read_b128 a[120:123], v54 offset:0
  ds_read_b128 a[124:127], v55 offset:0
  s_waitcnt lgkmcnt(0)
  v_mfma_f32_32x32x16_bf16 v[96:111], a[80:83], v[192:195], 0
  ds_read_b128 a[80:83], v40 offset:8192
  v_mfma_f32_32x32x16_bf16 v[96:111], a[84:87], v[196:199], v[96:111]
  ds_read_b128 a[84:87], v41 offset:8192
  v_mfma_f32_32x32x16_bf16 v[96:111], a[88:91], v[200:203], v[96:111]
  ds_read_b128 a[88:91], v42 offset:8192
  v_mfma_f32_32x32x16_bf16 v[96:111], a[92:95], v[204:207], v[96:111]
  ds_read_b128 a[92:95], v43 offset:8192
  v_mfma_f32_32x32x16_bf16 v[96:111], a[96:99], v[208:211], v[96:111]
  ds_read_b128 a[96:99], v44 offset:8192
  v_mfma_f32_32x32x16_bf16 v[96:111], a[100:103], v[212:215], v[96:111]
  ds_read_b128 a[100:103], v45 offset:8192
  v_mfma_f32_32x32x16_bf16 v[96:111], a[104:107], v[216:219], v[96:111]
  ds_read_b128 a[104:107], v46 offset:8192
  v_mfma_f32_32x32x16_bf16 v[96:111], a[108:111], v[220:223], v[96:111]
  ds_read_b128 a[108:111], v47 offset:8192
  v_mfma_f32_16x16x32_bf16 v[72:75], a[112:115], a[64:67], 0
  v_mfma_f32_16x16x32_bf16 v[72:75], a[116:119], a[68:71], v[72:75]
  v_mfma_f32_16x16x32_bf16 v[72:75], a[120:123], a[72:75], v[72:75]
  v_mfma_f32_16x16x32_bf16 v[72:75], a[124:127], a[76:79], v[72:75]
  s_waitcnt vmcnt(18) lgkmcnt(0)
  s_branch K1_S0_BAR
K1_ATT1:
  s_waitcnt vmcnt(26) lgkmcnt(0)
  s_barrier
  ds_read_b128 a[80:83], v40 offset:32768
  ds_read_b128 a[84:87], v41 offset:32768
  ds_read_b128 a[88:91], v42 offset:32768
  ds_read_b128 a[92:95], v43 offset:32768
  ds_read_b128 a[96:99], v44 offset:32768
  ds_read_b128 a[100:103], v45 offset:32768
  ds_read_b128 a[104:107], v46 offset:32768
  ds_read_b128 a[108:111], v47 offset:32768
  ds_read_b128 a[112:115], v52 offset:32768
  ds_read_b128 a[116:119], v53 offset:32768
  ds_read_b128 a[120:123], v54 offset:32768
  ds_read_b128 a[124:127], v55 offset:32768
  s_waitcnt lgkmcnt(0)
  v_mfma_f32_32x32x16_bf16 v[96:111], a[80:83], v[192:195], 0
  ds_read_b128 a[80:83], v40 offset:40960
  v_mfma_f32_32x32x16_bf16 v[96:111], a[84:87], v[196:199], v[96:111]
  ds_read_b128 a[84:87], v41 offset:40960
  v_mfma_f32_32x32x16_bf16 v[96:111], a[88:91], v[200:203], v[96:111]
  ds_read_b128 a[88:91], v42 offset:40960
  v_mfma_f32_32x32x16_bf16 v[96:111], a[92:95], v[204:207], v[96:111]
  ds_read_b128 a[92:95], v43 offset:40960
  v_mfma_f32_32x32x16_bf16 v[96:111], a[96:99], v[208:211], v[96:111]
  ds_read_b128 a[96:99], v44 offset:40960
  v_mfma_f32_32x32x16_bf16 v[96:111], a[100:103], v[212:215], v[96:111]
  ds_read_b128 a[100:103], v45 offset:40960
  v_mfma_f32_32x32x16_bf16 v[96:111], a[104:107], v[216:219], v[96:111]
  ds_read_b128 a[104:107], v46 offset:40960
  v_mfma_f32_32x32x16_bf16 v[96:111], a[108:111], v[220:223], v[96:111]
  ds_read_b128 a[108:111], v47 offset:40960
  v_mfma_f32_16x16x32_bf16 v[72:75], a[112:115], a[64:67], 0
  v_mfma_f32_16x16x32_bf16 v[72:75], a[116:119], a[68:71], v[72:75]
  v_mfma_f32_16x16x32_bf16 v[72:75], a[120:123], a[72:75], v[72:75]
  v_mfma_f32_16x16x32_bf16 v[72:75], a[124:127], a[76:79], v[72:75]
  s_waitcnt vmcnt(18) lgkmcnt(0)
  s_branch K1_S2_BAR
K1_S0:
  s_waitcnt vmcnt(8)
K1_S0_BAR:
  s_barrier
  s_cmp_eq_u32 s34, 7
  s_cbranch_scc0 K1_WO7
  s_cmp_eq_u32 s30, 1
  s_cbranch_scc0 K1_WO7
  s_mul_i32 s52, s2, 18432
  s_lshl_b32 s54, s3, 13
  s_add_u32 s52, s52, s54
  s_cmp_eq_u32 s3, 3
  s_cbranch_scc1 K1_PFWO_D
  buffer_load_dword v67, v68, s[24:27], s52 offen
K1_PFWO_D:
K1_WO7:
  v_mfma_f32_32x32x16_bf16 v[112:127], a[80:83], v[192:195], 0
  ds_read_b128 a[80:83], v40 offset:16384
  s_add_u32 m0, s38, 0
  v_exp_f32 v96, v96
  v_exp_f32 v97, v97
  v_mfma_f32_32x32x16_bf16 v[112:127], a[84:87], v[196:199], v[112:127]
  ds_read_b128 a[84:87], v41 offset:16384
  buffer_load_dwordx4 v34, s[12:15], s35 offen offset:0 nt lds
  v_add_f32 v64, v64, v96
  v_exp_f32 v98, v98
  v_mfma_f32_32x32x16_bf16 v[112:127], a[88:91], v[200:203], v[112:127]
  ds_read_b128 a[88:91], v42 offset:16384
  v_add_f32 v64, v64, v97
  v_cvt_pk_bf16_f32 v80, v96, v97
  v_exp_f32 v99, v99
  v_mfma_f32_32x32x16_bf16 v[112:127], a[92:95], v[204:207], v[112:127]
  ds_read_b128 a[92:95], v43 offset:16384
  v_add_f32 v64, v64, v98
  v_exp_f32 v100, v100
  v_add_f32 v64, v64, v99
  v_cvt_pk_bf16_f32 v81, v98, v99
  v_mfma_f32_32x32x16_bf16 v[112:127], a[96:99], v[208:211], v[112:127]
  ds_read_b128 a[96:99], v44 offset:16384
  v_exp_f32 v101, v101
  v_add_f32 v64, v64, v100
  v_exp_f32 v102, v102
  v_mfma_f32_32x32x16_bf16 v[112:127], a[100:103], v[212:215], v[112:127]
  ds_read_b128 a[100:103], v45 offset:16384
  buffer_load_dwordx4 v35, s[12:15], s35 offen offset:1024 nt lds
  v_add_f32 v64, v64, v101
  v_cvt_pk_bf16_f32 v82, v100, v101
  v_mfma_f32_32x32x16_bf16 v[112:127], a[104:107], v[216:219], v[112:127]
  ds_read_b128 a[104:107], v46 offset:16384
  v_exp_f32 v103, v103
  v_add_f32 v64, v64, v102
  v_exp_f32 v104, v104
  v_mfma_f32_32x32x16_bf16 v[112:127], a[108:111], v[220:223], v[112:127]
  ds_read_b128 a[108:111], v47 offset:16384
  v_add_f32 v64, v64, v103
  v_cvt_pk_bf16_f32 v83, v102, v103
  v_exp_f32 v105, v105
  s_waitcnt lgkmcnt(15)
  v_mfma_f32_32x32x16_bf16 v[128:143], a[128:131], v[88:91], v[128:143]
  ds_read_b64_tr_b16 a[128:129], v48 offset:0
  ds_read_b64_tr_b16 a[130:131], v48 offset:2048
  v_add_f32 v64, v64, v104
  v_exp_f32 v106, v106
  v_mfma_f32_32x32x16_bf16 v[144:159], a[132:135], v[88:91], v[144:159]
  ds_read_b64_tr_b16 a[132:133], v49 offset:0
  ds_read_b64_tr_b16 a[134:135], v49 offset:2048
  buffer_load_dwordx4 v36, s[12:15], s35 offen offset:2048 nt lds
  v_add_f32 v64, v64, v105
  v_cvt_pk_bf16_f32 v84, v104, v105
  v_mfma_f32_32x32x16_bf16 v[160:175], a[136:139], v[88:91], v[160:175]
  ds_read_b64_tr_b16 a[136:137], v50 offset:0
  ds_read_b64_tr_b16 a[138:139], v50 offset:2048
  v_exp_f32 v107, v107
  v_add_f32 v64, v64, v106
  v_mfma_f32_32x32x16_bf16 v[176:191], a[140:143], v[88:91], v[176:191]
  ds_read_b64_tr_b16 a[140:141], v51 offset:0
  ds_read_b64_tr_b16 a[142:143], v51 offset:2048
  v_exp_f32 v108, v108
  v_add_f32 v64, v64, v107
  v_cvt_pk_bf16_f32 v85, v106, v107
  s_waitcnt lgkmcnt(15)
  v_mfma_f32_32x32x16_bf16 v[128:143], a[144:147], v[92:95], v[128:143]
  ds_read_b64_tr_b16 a[144:145], v48 offset:4096
  ds_read_b64_tr_b16 a[146:147], v48 offset:6144
  v_exp_f32 v109, v109
  v_add_f32 v64, v64, v108
  v_mfma_f32_32x32x16_bf16 v[144:159], a[148:151], v[92:95], v[144:159]
  ds_read_b64_tr_b16 a[148:149], v49 offset:4096
  ds_read_b64_tr_b16 a[150:151], v49 offset:6144
  buffer_load_dwordx4 v37, s[12:15], s35 offen offset:3072 nt lds
  s_cmp_eq_u32 s34, 4
  v_exp_f32 v110, v110
  v_mfma_f32_32x32x16_bf16 v[160:175], a[152:155], v[92:95], v[160:175]
  ds_read_b64_tr_b16 a[152:153], v50 offset:4096
  ds_read_b64_tr_b16 a[154:155], v50 offset:6144
  s_cselect_b32 s40, s96, s51
  v_add_f32 v64, v64, v109
  v_cvt_pk_bf16_f32 v86, v108, v109
  v_exp_f32 v111, v111
  v_mfma_f32_32x32x16_bf16 v[176:191], a[156:159], v[92:95], v[176:191]
  ds_read_b64_tr_b16 a[156:157], v51 offset:4096
  ds_read_b64_tr_b16 a[158:159], v51 offset:6144
  s_add_u32 s35, s35, s40
  v_add_f32 v64, v64, v110
  v_add_f32 v64, v64, v111
  v_cvt_pk_bf16_f32 v87, v110, v111
  v_mfma_f32_32x32x16_bf16 v[96:111], a[80:83], v[192:195], 0
  ds_read_b128 a[80:83], v40 offset:24576
  ds_read_b128 a[112:115], v52 offset:16384
  s_add_u32 m0, s38, 81920
  v_exp_f32 v72, v72
  v_exp_f32 v73, v73
  s_waitcnt lgkmcnt(15)
  v_mfma_f32_32x32x16_bf16 v[96:111], a[84:87], v[196:199], v[96:111]
  ds_read_b128 a[84:87], v41 offset:24576
  ds_read_b128 a[116:119], v53 offset:16384
  buffer_load_dwordx4 v38, s[16:19], s36 offen offset:0 nt lds
  v_add_f32 v66, v66, v72
  v_mfma_f32_32x32x16_bf16 v[96:111], a[88:91], v[200:203], v[96:111]
  ds_read_b128 a[88:91], v42 offset:24576
  ds_read_b128 a[120:123], v54 offset:16384
  v_exp_f32 v74, v74
  v_add_f32 v66, v66, v73
  v_cvt_pk_bf16_f32 v70, v72, v73
  v_mfma_f32_32x32x16_bf16 v[96:111], a[92:95], v[204:207], v[96:111]
  ds_read_b128 a[92:95], v43 offset:24576
  ds_read_b128 a[124:127], v55 offset:16384
  v_exp_f32 v75, v75
  v_add_f32 v66, v66, v74
  v_add_f32 v66, v66, v75
  v_mfma_f32_32x32x16_bf16 v[96:111], a[96:99], v[208:211], v[96:111]
  ds_read_b128 a[96:99], v44 offset:24576
  ds_read_b64_tr_b16 a[160:161], v56 offset:0
  v_cvt_pk_bf16_f32 v71, v74, v75
  v_exp_f32 v112, v112
  v_mfma_f32_32x32x16_bf16 v[96:111], a[100:103], v[212:215], v[96:111]
  ds_read_b128 a[100:103], v45 offset:24576
  ds_read_b64_tr_b16 a[162:163], v57 offset:0
  v_exp_f32 v113, v113
  v_add_f32 v64, v64, v112
  v_exp_f32 v114, v114
  v_mfma_f32_32x32x16_bf16 v[96:111], a[104:107], v[216:219], v[96:111]
  ds_read_b128 a[104:107], v46 offset:24576
  ds_read_b64_tr_b16 a[164:165], v58 offset:0
  buffer_load_dwordx4 v39, s[16:19], s36 offen offset:1024 nt lds
  v_add_f32 v64, v64, v113
  v_mfma_f32_32x32x16_bf16 v[96:111], a[108:111], v[220:223], v[96:111]
  ds_read_b128 a[108:111], v47 offset:24576
  ds_read_b64_tr_b16 a[166:167], v59 offset:0
  v_cvt_pk_bf16_f32 v88, v112, v113
  v_exp_f32 v115, v115
  v_add_f32 v64, v64, v114
  s_waitcnt lgkmcnt(14)
  v_mfma_f32_16x16x32_bf16 v[72:75], a[112:115], a[64:67], 0
  ds_read_b64_tr_b16 a[168:169], v60 offset:0
  s_waitcnt lgkmcnt(13)
  v_mfma_f32_16x16x32_bf16 v[72:75], a[116:119], a[68:71], v[72:75]
  ds_read_b64_tr_b16 a[170:171], v61 offset:0
  v_exp_f32 v116, v116
  s_waitcnt lgkmcnt(12)
  v_mfma_f32_16x16x32_bf16 v[72:75], a[120:123], a[72:75], v[72:75]
  ds_read_b64_tr_b16 a[172:173], v62 offset:0
  s_waitcnt lgkmcnt(11)
  v_mfma_f32_16x16x32_bf16 v[72:75], a[124:127], a[76:79], v[72:75]
  ds_read_b64_tr_b16 a[174:175], v63 offset:0
  v_add_f32 v64, v64, v115
  v_mfma_f32_32x32x16_bf16 v[128:143], a[128:131], v[80:83], v[128:143]
  ds_read_b64_tr_b16 a[128:129], v48 offset:8192
  ds_read_b64_tr_b16 a[130:131], v48 offset:10240
  v_cvt_pk_bf16_f32 v89, v114, v115
  v_exp_f32 v117, v117
  v_add_f32 v64, v64, v116
  v_mfma_f32_32x32x16_bf16 v[144:159], a[132:135], v[80:83], v[144:159]
  ds_read_b64_tr_b16 a[132:133], v49 offset:8192
  ds_read_b64_tr_b16 a[134:135], v49 offset:10240
  buffer_load_dwordx4 v38, s[16:19], s36 offen offset:2048 nt lds
  v_exp_f32 v118, v118
  v_mfma_f32_32x32x16_bf16 v[160:175], a[136:139], v[80:83], v[160:175]
  ds_read_b64_tr_b16 a[136:137], v50 offset:8192
  ds_read_b64_tr_b16 a[138:139], v50 offset:10240
  v_add_f32 v64, v64, v117
  v_cvt_pk_bf16_f32 v90, v116, v117
  v_exp_f32 v119, v119
  v_mfma_f32_32x32x16_bf16 v[176:191], a[140:143], v[80:83], v[176:191]
  ds_read_b64_tr_b16 a[140:141], v51 offset:8192
  ds_read_b64_tr_b16 a[142:143], v51 offset:10240
  v_add_f32 v64, v64, v118
  v_exp_f32 v120, v120
  v_mfma_f32_32x32x16_bf16 v[128:143], a[144:147], v[84:87], v[128:143]
  ds_read_b64_tr_b16 a[144:145], v48 offset:12288
  ds_read_b64_tr_b16 a[146:147], v48 offset:14336
  v_add_f32 v64, v64, v119
  v_cvt_pk_bf16_f32 v91, v118, v119
  v_exp_f32 v121, v121
  v_mfma_f32_32x32x16_bf16 v[144:159], a[148:151], v[84:87], v[144:159]
  ds_read_b64_tr_b16 a[148:149], v49 offset:12288
  ds_read_b64_tr_b16 a[150:151], v49 offset:14336
  v_add_f32 v64, v64, v120
  v_exp_f32 v122, v122
  v_add_f32 v64, v64, v121
  v_mfma_f32_32x32x16_bf16 v[160:175], a[152:155], v[84:87], v[160:175]
  ds_read_b64_tr_b16 a[152:153], v50 offset:12288
  ds_read_b64_tr_b16 a[154:155], v50 offset:14336
  buffer_load_dwordx4 v39, s[16:19], s36 offen offset:3072 nt lds
  s_cmp_eq_u32 s34, 5
  v_cvt_pk_bf16_f32 v92, v120, v121
  v_mfma_f32_32x32x16_bf16 v[176:191], a[156:159], v[84:87], v[176:191]
  ds_read_b64_tr_b16 a[156:157], v51 offset:12288
  ds_read_b64_tr_b16 a[158:159], v51 offset:14336
  s_cselect_b32 s41, s96, s51
  v_exp_f32 v123, v123
  v_add_f32 v64, v64, v122
  v_exp_f32 v124, v124
  s_waitcnt lgkmcnt(15)
  v_mfma_f32_16x16x16_bf16 a[176:179], a[160:161], v[70:71], a[176:179]
  s_add_u32 s36, s36, s41
  v_add_f32 v64, v64, v123
  v_mfma_f32_16x16x16_bf16 a[180:183], a[162:163], v[70:71], a[180:183]
  v_cvt_pk_bf16_f32 v93, v122, v123
  v_mfma_f32_16x16x16_bf16 a[184:187], a[164:165], v[70:71], a[184:187]
  v_exp_f32 v125, v125
  v_add_f32 v64, v64, v124
  v_mfma_f32_16x16x16_bf16 a[188:191], a[166:167], v[70:71], a[188:191]
  v_exp_f32 v126, v126
  v_mfma_f32_16x16x16_bf16 a[192:195], a[168:169], v[70:71], a[192:195]
  v_add_f32 v64, v64, v125
  v_mfma_f32_16x16x16_bf16 a[196:199], a[170:171], v[70:71], a[196:199]
  v_cvt_pk_bf16_f32 v94, v124, v125
  v_exp_f32 v127, v127
  v_mfma_f32_16x16x16_bf16 a[200:203], a[172:173], v[70:71], a[200:203]
  v_add_f32 v64, v64, v126
  v_mfma_f32_16x16x16_bf16 a[204:207], a[174:175], v[70:71], a[204:207]
  v_add_f32 v64, v64, v127
  v_cvt_pk_bf16_f32 v95, v126, v127
  s_add_u32 s34, s34, 1
  s_cmp_eq_u32 s34, 8
  s_cbranch_scc1 K1_DRAIN
K1_S1:
  s_waitcnt vmcnt(8)
K1_S1_BAR:
  s_barrier
  s_cmp_eq_u32 s34, 2
  s_cbranch_scc0 K1_SIGa
  s_bitcmp1_b32 s95, 0
  s_cbranch_scc1 K1_SIGa
  s_cmp_eq_u32 s3, 0
  s_cbranch_scc0 K1_SIGa
  s_lshl_b32 s40, s28, 4
  s_add_u32 s40, s40, s29
  s_lshl_b32 s40, s40, 7
  s_add_u32 s40, s40, 19922944
  v_mov_b32 v242, s40
  v_mov_b32 v243, s97
  s_mov_b64 exec, 1
  global_store_dword v242, v243, s[20:21] sc1
  s_mov_b64 exec, -1
K1_SIGa:
  v_mfma_f32_32x32x16_bf16 v[112:127], a[80:83], v[192:195], 0
  ds_read_b128 a[80:83], v40 offset:32768
  s_add_u32 m0, s38, 16384
  v_exp_f32 v96, v96
  v_exp_f32 v97, v97
  v_mfma_f32_32x32x16_bf16 v[112:127], a[84:87], v[196:199], v[112:127]
  ds_read_b128 a[84:87], v41 offset:32768
  buffer_load_dwordx4 v34, s[12:15], s35 offen offset:0 nt lds
  v_add_f32 v64, v64, v96
  v_exp_f32 v98, v98
  v_mfma_f32_32x32x16_bf16 v[112:127], a[88:91], v[200:203], v[112:127]
  ds_read_b128 a[88:91], v42 offset:32768
  v_add_f32 v64, v64, v97
  v_cvt_pk_bf16_f32 v80, v96, v97
  v_exp_f32 v99, v99
  v_mfma_f32_32x32x16_bf16 v[112:127], a[92:95], v[204:207], v[112:127]
  ds_read_b128 a[92:95], v43 offset:32768
  v_add_f32 v64, v64, v98
  v_exp_f32 v100, v100
  v_add_f32 v64, v64, v99
  v_cvt_pk_bf16_f32 v81, v98, v99
  v_mfma_f32_32x32x16_bf16 v[112:127], a[96:99], v[208:211], v[112:127]
  ds_read_b128 a[96:99], v44 offset:32768
  v_exp_f32 v101, v101
  v_add_f32 v64, v64, v100
  v_exp_f32 v102, v102
  v_mfma_f32_32x32x16_bf16 v[112:127], a[100:103], v[212:215], v[112:127]
  ds_read_b128 a[100:103], v45 offset:32768
  buffer_load_dwordx4 v35, s[12:15], s35 offen offset:1024 nt lds
  v_add_f32 v64, v64, v101
  v_cvt_pk_bf16_f32 v82, v100, v101
  v_mfma_f32_32x32x16_bf16 v[112:127], a[104:107], v[216:219], v[112:127]
  ds_read_b128 a[104:107], v46 offset:32768
  v_exp_f32 v103, v103
  v_add_f32 v64, v64, v102
  v_exp_f32 v104, v104
  v_mfma_f32_32x32x16_bf16 v[112:127], a[108:111], v[220:223], v[112:127]
  ds_read_b128 a[108:111], v47 offset:32768
  v_add_f32 v64, v64, v103
  v_cvt_pk_bf16_f32 v83, v102, v103
  v_exp_f32 v105, v105
  s_waitcnt lgkmcnt(15)
  v_mfma_f32_32x32x16_bf16 v[128:143], a[128:131], v[88:91], v[128:143]
  ds_read_b64_tr_b16 a[128:129], v48 offset:16384
  ds_read_b64_tr_b16 a[130:131], v48 offset:18432
  v_add_f32 v64, v64, v104
  v_exp_f32 v106, v106
  v_mfma_f32_32x32x16_bf16 v[144:159], a[132:135], v[88:91], v[144:159]
  ds_read_b64_tr_b16 a[132:133], v49 offset:16384
  ds_read_b64_tr_b16 a[134:135], v49 offset:18432
  buffer_load_dwordx4 v36, s[12:15], s35 offen offset:2048 nt lds
  v_add_f32 v64, v64, v105
  v_cvt_pk_bf16_f32 v84, v104, v105
  v_mfma_f32_32x32x16_bf16 v[160:175], a[136:139], v[88:91], v[160:175]
  ds_read_b64_tr_b16 a[136:137], v50 offset:16384
  ds_read_b64_tr_b16 a[138:139], v50 offset:18432
  v_exp_f32 v107, v107
  v_add_f32 v64, v64, v106
  v_mfma_f32_32x32x16_bf16 v[176:191], a[140:143], v[88:91], v[176:191]
  ds_read_b64_tr_b16 a[140:141], v51 offset:16384
  ds_read_b64_tr_b16 a[142:143], v51 offset:18432
  v_exp_f32 v108, v108
  v_add_f32 v64, v64, v107
  v_cvt_pk_bf16_f32 v85, v106, v107
  s_waitcnt lgkmcnt(15)
  v_mfma_f32_32x32x16_bf16 v[128:143], a[144:147], v[92:95], v[128:143]
  ds_read_b64_tr_b16 a[144:145], v48 offset:20480
  ds_read_b64_tr_b16 a[146:147], v48 offset:22528
  v_exp_f32 v109, v109
  v_add_f32 v64, v64, v108
  v_mfma_f32_32x32x16_bf16 v[144:159], a[148:151], v[92:95], v[144:159]
  ds_read_b64_tr_b16 a[148:149], v49 offset:20480
  ds_read_b64_tr_b16 a[150:151], v49 offset:22528
  buffer_load_dwordx4 v37, s[12:15], s35 offen offset:3072 nt lds
  s_cmp_eq_u32 s34, 4
  v_exp_f32 v110, v110
  v_mfma_f32_32x32x16_bf16 v[160:175], a[152:155], v[92:95], v[160:175]
  ds_read_b64_tr_b16 a[152:153], v50 offset:20480
  ds_read_b64_tr_b16 a[154:155], v50 offset:22528
  s_cselect_b32 s40, s96, s51
  v_add_f32 v64, v64, v109
  v_cvt_pk_bf16_f32 v86, v108, v109
  v_exp_f32 v111, v111
  v_mfma_f32_32x32x16_bf16 v[176:191], a[156:159], v[92:95], v[176:191]
  ds_read_b64_tr_b16 a[156:157], v51 offset:20480
  ds_read_b64_tr_b16 a[158:159], v51 offset:22528
  s_add_u32 s35, s35, s40
  v_add_f32 v64, v64, v110
  v_add_f32 v64, v64, v111
  v_cvt_pk_bf16_f32 v87, v110, v111
  v_mfma_f32_32x32x16_bf16 v[96:111], a[80:83], v[192:195], 0
  ds_read_b128 a[80:83], v40 offset:40960
  ds_read_b128 a[112:115], v52 offset:32768
  s_add_u32 m0, s38, 49152
  v_exp_f32 v72, v72
  v_exp_f32 v73, v73
  s_waitcnt lgkmcnt(15)
  v_mfma_f32_32x32x16_bf16 v[96:111], a[84:87], v[196:199], v[96:111]
  ds_read_b128 a[84:87], v41 offset:40960
  ds_read_b128 a[116:119], v53 offset:32768
  buffer_load_dwordx4 v38, s[16:19], s36 offen offset:0 nt lds
  v_add_f32 v66, v66, v72
  v_mfma_f32_32x32x16_bf16 v[96:111], a[88:91], v[200:203], v[96:111]
  ds_read_b128 a[88:91], v42 offset:40960
  ds_read_b128 a[120:123], v54 offset:32768
  v_exp_f32 v74, v74
  v_add_f32 v66, v66, v73
  v_cvt_pk_bf16_f32 v70, v72, v73
  v_mfma_f32_32x32x16_bf16 v[96:111], a[92:95], v[204:207], v[96:111]
  ds_read_b128 a[92:95], v43 offset:40960
  ds_read_b128 a[124:127], v55 offset:32768
  v_exp_f32 v75, v75
  v_add_f32 v66, v66, v74
  v_add_f32 v66, v66, v75
  v_mfma_f32_32x32x16_bf16 v[96:111], a[96:99], v[208:211], v[96:111]
  ds_read_b128 a[96:99], v44 offset:40960
  ds_read_b64_tr_b16 a[160:161], v56 offset:16384
  v_cvt_pk_bf16_f32 v71, v74, v75
  v_exp_f32 v112, v112
  v_mfma_f32_32x32x16_bf16 v[96:111], a[100:103], v[212:215], v[96:111]
  ds_read_b128 a[100:103], v45 offset:40960
  ds_read_b64_tr_b16 a[162:163], v57 offset:16384
  v_exp_f32 v113, v113
  v_add_f32 v64, v64, v112
  v_exp_f32 v114, v114
  v_mfma_f32_32x32x16_bf16 v[96:111], a[104:107], v[216:219], v[96:111]
  ds_read_b128 a[104:107], v46 offset:40960
  ds_read_b64_tr_b16 a[164:165], v58 offset:16384
  buffer_load_dwordx4 v39, s[16:19], s36 offen offset:1024 nt lds
  v_add_f32 v64, v64, v113
  v_mfma_f32_32x32x16_bf16 v[96:111], a[108:111], v[220:223], v[96:111]
  ds_read_b128 a[108:111], v47 offset:40960
  ds_read_b64_tr_b16 a[166:167], v59 offset:16384
  v_cvt_pk_bf16_f32 v88, v112, v113
  v_exp_f32 v115, v115
  v_add_f32 v64, v64, v114
  s_waitcnt lgkmcnt(14)
  v_mfma_f32_16x16x32_bf16 v[72:75], a[112:115], a[64:67], 0
  ds_read_b64_tr_b16 a[168:169], v60 offset:16384
  s_waitcnt lgkmcnt(13)
  v_mfma_f32_16x16x32_bf16 v[72:75], a[116:119], a[68:71], v[72:75]
  ds_read_b64_tr_b16 a[170:171], v61 offset:16384
  v_exp_f32 v116, v116
  s_waitcnt lgkmcnt(12)
  v_mfma_f32_16x16x32_bf16 v[72:75], a[120:123], a[72:75], v[72:75]
  ds_read_b64_tr_b16 a[172:173], v62 offset:16384
  s_waitcnt lgkmcnt(11)
  v_mfma_f32_16x16x32_bf16 v[72:75], a[124:127], a[76:79], v[72:75]
  ds_read_b64_tr_b16 a[174:175], v63 offset:16384
  v_add_f32 v64, v64, v115
  v_mfma_f32_32x32x16_bf16 v[128:143], a[128:131], v[80:83], v[128:143]
  ds_read_b64_tr_b16 a[128:129], v48 offset:24576
  ds_read_b64_tr_b16 a[130:131], v48 offset:26624
  v_cvt_pk_bf16_f32 v89, v114, v115
  v_exp_f32 v117, v117
  v_add_f32 v64, v64, v116
  v_mfma_f32_32x32x16_bf16 v[144:159], a[132:135], v[80:83], v[144:159]
  ds_read_b64_tr_b16 a[132:133], v49 offset:24576
  ds_read_b64_tr_b16 a[134:135], v49 offset:26624
  buffer_load_dwordx4 v38, s[16:19], s36 offen offset:2048 nt lds
  v_exp_f32 v118, v118
  v_mfma_f32_32x32x16_bf16 v[160:175], a[136:139], v[80:83], v[160:175]
  ds_read_b64_tr_b16 a[136:137], v50 offset:24576
  ds_read_b64_tr_b16 a[138:139], v50 offset:26624
  v_add_f32 v64, v64, v117
  v_cvt_pk_bf16_f32 v90, v116, v117
  v_exp_f32 v119, v119
  v_mfma_f32_32x32x16_bf16 v[176:191], a[140:143], v[80:83], v[176:191]
  ds_read_b64_tr_b16 a[140:141], v51 offset:24576
  ds_read_b64_tr_b16 a[142:143], v51 offset:26624
  v_add_f32 v64, v64, v118
  v_exp_f32 v120, v120
  v_mfma_f32_32x32x16_bf16 v[128:143], a[144:147], v[84:87], v[128:143]
  ds_read_b64_tr_b16 a[144:145], v48 offset:28672
  ds_read_b64_tr_b16 a[146:147], v48 offset:30720
  v_add_f32 v64, v64, v119
  v_cvt_pk_bf16_f32 v91, v118, v119
  v_exp_f32 v121, v121
  v_mfma_f32_32x32x16_bf16 v[144:159], a[148:151], v[84:87], v[144:159]
  ds_read_b64_tr_b16 a[148:149], v49 offset:28672
  ds_read_b64_tr_b16 a[150:151], v49 offset:30720
  v_add_f32 v64, v64, v120
  v_exp_f32 v122, v122
  v_add_f32 v64, v64, v121
  v_mfma_f32_32x32x16_bf16 v[160:175], a[152:155], v[84:87], v[160:175]
  ds_read_b64_tr_b16 a[152:153], v50 offset:28672
  ds_read_b64_tr_b16 a[154:155], v50 offset:30720
  buffer_load_dwordx4 v39, s[16:19], s36 offen offset:3072 nt lds
  s_cmp_eq_u32 s34, 5
  v_cvt_pk_bf16_f32 v92, v120, v121
  v_mfma_f32_32x32x16_bf16 v[176:191], a[156:159], v[84:87], v[176:191]
  ds_read_b64_tr_b16 a[156:157], v51 offset:28672
  ds_read_b64_tr_b16 a[158:159], v51 offset:30720
  s_cselect_b32 s41, s96, s51
  v_exp_f32 v123, v123
  v_add_f32 v64, v64, v122
  v_exp_f32 v124, v124
  s_waitcnt lgkmcnt(15)
  v_mfma_f32_16x16x16_bf16 a[176:179], a[160:161], v[70:71], a[176:179]
  s_add_u32 s36, s36, s41
  v_add_f32 v64, v64, v123
  v_mfma_f32_16x16x16_bf16 a[180:183], a[162:163], v[70:71], a[180:183]
  v_cvt_pk_bf16_f32 v93, v122, v123
  v_mfma_f32_16x16x16_bf16 a[184:187], a[164:165], v[70:71], a[184:187]
  v_exp_f32 v125, v125
  v_add_f32 v64, v64, v124
  v_mfma_f32_16x16x16_bf16 a[188:191], a[166:167], v[70:71], a[188:191]
  v_exp_f32 v126, v126
  v_mfma_f32_16x16x16_bf16 a[192:195], a[168:169], v[70:71], a[192:195]
  v_add_f32 v64, v64, v125
  v_mfma_f32_16x16x16_bf16 a[196:199], a[170:171], v[70:71], a[196:199]
  v_cvt_pk_bf16_f32 v94, v124, v125
  v_exp_f32 v127, v127
  v_mfma_f32_16x16x16_bf16 a[200:203], a[172:173], v[70:71], a[200:203]
  v_add_f32 v64, v64, v126
  v_mfma_f32_16x16x16_bf16 a[204:207], a[174:175], v[70:71], a[204:207]
  v_add_f32 v64, v64, v127
  v_cvt_pk_bf16_f32 v95, v126, v127
  s_add_u32 s34, s34, 1
  s_cmp_eq_u32 s34, 8
  s_cbranch_scc1 K1_DRAIN
K1_S2:
  s_waitcnt vmcnt(8)
K1_S2_BAR:
  s_barrier
  v_mfma_f32_32x32x16_bf16 v[112:127], a[80:83], v[192:195], 0
  ds_read_b128 a[80:83], v40 offset:0
  s_add_u32 m0, s38, 32768
  v_exp_f32 v96, v96
  v_exp_f32 v97, v97
  v_mfma_f32_32x32x16_bf16 v[112:127], a[84:87], v[196:199], v[112:127]
  ds_read_b128 a[84:87], v41 offset:0
  buffer_load_dwordx4 v34, s[12:15], s35 offen offset:0 nt lds
  v_add_f32 v64, v64, v96
  v_exp_f32 v98, v98
  v_mfma_f32_32x32x16_bf16 v[112:127], a[88:91], v[200:203], v[112:127]
  ds_read_b128 a[88:91], v42 offset:0
  v_add_f32 v64, v64, v97
  v_cvt_pk_bf16_f32 v80, v96, v97
  v_exp_f32 v99, v99
  v_mfma_f32_32x32x16_bf16 v[112:127], a[92:95], v[204:207], v[112:127]
  ds_read_b128 a[92:95], v43 offset:0
  v_add_f32 v64, v64, v98
  v_exp_f32 v100, v100
  v_add_f32 v64, v64, v99
  v_cvt_pk_bf16_f32 v81, v98, v99
  v_mfma_f32_32x32x16_bf16 v[112:127], a[96:99], v[208:211], v[112:127]
  ds_read_b128 a[96:99], v44 offset:0
  v_exp_f32 v101, v101
  v_add_f32 v64, v64, v100
  v_exp_f32 v102, v102
  v_mfma_f32_32x32x16_bf16 v[112:127], a[100:103], v[212:215], v[112:127]
  ds_read_b128 a[100:103], v45 offset:0
  buffer_load_dwordx4 v35, s[12:15], s35 offen offset:1024 nt lds
  v_add_f32 v64, v64, v101
  v_cvt_pk_bf16_f32 v82, v100, v101
  v_mfma_f32_32x32x16_bf16 v[112:127], a[104:107], v[216:219], v[112:127]
  ds_read_b128 a[104:107], v46 offset:0
  v_exp_f32 v103, v103
  v_add_f32 v64, v64, v102
  v_exp_f32 v104, v104
  v_mfma_f32_32x32x16_bf16 v[112:127], a[108:111], v[220:223], v[112:127]
  ds_read_b128 a[108:111], v47 offset:0
  v_add_f32 v64, v64, v103
  v_cvt_pk_bf16_f32 v83, v102, v103
  v_exp_f32 v105, v105
  s_waitcnt lgkmcnt(15)
  v_mfma_f32_32x32x16_bf16 v[128:143], a[128:131], v[88:91], v[128:143]
  ds_read_b64_tr_b16 a[128:129], v48 offset:32768
  ds_read_b64_tr_b16 a[130:131], v48 offset:34816
  v_add_f32 v64, v64, v104
  v_exp_f32 v106, v106
  v_mfma_f32_32x32x16_bf16 v[144:159], a[132:135], v[88:91], v[144:159]
  ds_read_b64_tr_b16 a[132:133], v49 offset:32768
  ds_read_b64_tr_b16 a[134:135], v49 offset:34816
  buffer_load_dwordx4 v36, s[12:15], s35 offen offset:2048 nt lds
  v_add_f32 v64, v64, v105
  v_cvt_pk_bf16_f32 v84, v104, v105
  v_mfma_f32_32x32x16_bf16 v[160:175], a[136:139], v[88:91], v[160:175]
  ds_read_b64_tr_b16 a[136:137], v50 offset:32768
  ds_read_b64_tr_b16 a[138:139], v50 offset:34816
  v_exp_f32 v107, v107
  v_add_f32 v64, v64, v106
  v_mfma_f32_32x32x16_bf16 v[176:191], a[140:143], v[88:91], v[176:191]
  ds_read_b64_tr_b16 a[140:141], v51 offset:32768
  ds_read_b64_tr_b16 a[142:143], v51 offset:34816
  v_exp_f32 v108, v108
  v_add_f32 v64, v64, v107
  v_cvt_pk_bf16_f32 v85, v106, v107
  s_waitcnt lgkmcnt(15)
  v_mfma_f32_32x32x16_bf16 v[128:143], a[144:147], v[92:95], v[128:143]
  ds_read_b64_tr_b16 a[144:145], v48 offset:36864
  ds_read_b64_tr_b16 a[146:147], v48 offset:38912
  v_exp_f32 v109, v109
  v_add_f32 v64, v64, v108
  v_mfma_f32_32x32x16_bf16 v[144:159], a[148:151], v[92:95], v[144:159]
  ds_read_b64_tr_b16 a[148:149], v49 offset:36864
  ds_read_b64_tr_b16 a[150:151], v49 offset:38912
  buffer_load_dwordx4 v37, s[12:15], s35 offen offset:3072 nt lds
  s_cmp_eq_u32 s34, 4
  v_exp_f32 v110, v110
  v_mfma_f32_32x32x16_bf16 v[160:175], a[152:155], v[92:95], v[160:175]
  ds_read_b64_tr_b16 a[152:153], v50 offset:36864
  ds_read_b64_tr_b16 a[154:155], v50 offset:38912
  s_cselect_b32 s40, s96, s51
  v_add_f32 v64, v64, v109
  v_cvt_pk_bf16_f32 v86, v108, v109
  v_exp_f32 v111, v111
  v_mfma_f32_32x32x16_bf16 v[176:191], a[156:159], v[92:95], v[176:191]
  ds_read_b64_tr_b16 a[156:157], v51 offset:36864
  ds_read_b64_tr_b16 a[158:159], v51 offset:38912
  s_add_u32 s35, s35, s40
  v_add_f32 v64, v64, v110
  v_add_f32 v64, v64, v111
  v_cvt_pk_bf16_f32 v87, v110, v111
  v_mfma_f32_32x32x16_bf16 v[96:111], a[80:83], v[192:195], 0
  ds_read_b128 a[80:83], v40 offset:8192
  ds_read_b128 a[112:115], v52 offset:0
  s_add_u32 m0, s38, 65536
  v_exp_f32 v72, v72
  v_exp_f32 v73, v73
  s_waitcnt lgkmcnt(15)
  v_mfma_f32_32x32x16_bf16 v[96:111], a[84:87], v[196:199], v[96:111]
  ds_read_b128 a[84:87], v41 offset:8192
  ds_read_b128 a[116:119], v53 offset:0
  buffer_load_dwordx4 v38, s[16:19], s36 offen offset:0 nt lds
  v_add_f32 v66, v66, v72
  v_mfma_f32_32x32x16_bf16 v[96:111], a[88:91], v[200:203], v[96:111]
  ds_read_b128 a[88:91], v42 offset:8192
  ds_read_b128 a[120:123], v54 offset:0
  v_exp_f32 v74, v74
  v_add_f32 v66, v66, v73
  v_cvt_pk_bf16_f32 v70, v72, v73
  v_mfma_f32_32x32x16_bf16 v[96:111], a[92:95], v[204:207], v[96:111]
  ds_read_b128 a[92:95], v43 offset:8192
  ds_read_b128 a[124:127], v55 offset:0
  v_exp_f32 v75, v75
  v_add_f32 v66, v66, v74
  v_add_f32 v66, v66, v75
  v_mfma_f32_32x32x16_bf16 v[96:111], a[96:99], v[208:211], v[96:111]
  ds_read_b128 a[96:99], v44 offset:8192
  ds_read_b64_tr_b16 a[160:161], v56 offset:32768
  v_cvt_pk_bf16_f32 v71, v74, v75
  v_exp_f32 v112, v112
  v_mfma_f32_32x32x16_bf16 v[96:111], a[100:103], v[212:215], v[96:111]
  ds_read_b128 a[100:103], v45 offset:8192
  ds_read_b64_tr_b16 a[162:163], v57 offset:32768
  v_exp_f32 v113, v113
  v_add_f32 v64, v64, v112
  v_exp_f32 v114, v114
  v_mfma_f32_32x32x16_bf16 v[96:111], a[104:107], v[216:219], v[96:111]
  ds_read_b128 a[104:107], v46 offset:8192
  ds_read_b64_tr_b16 a[164:165], v58 offset:32768
  buffer_load_dwordx4 v39, s[16:19], s36 offen offset:1024 nt lds
  v_add_f32 v64, v64, v113
  v_mfma_f32_32x32x16_bf16 v[96:111], a[108:111], v[220:223], v[96:111]
  ds_read_b128 a[108:111], v47 offset:8192
  ds_read_b64_tr_b16 a[166:167], v59 offset:32768
  v_cvt_pk_bf16_f32 v88, v112, v113
  v_exp_f32 v115, v115
  v_add_f32 v64, v64, v114
  s_waitcnt lgkmcnt(14)
  v_mfma_f32_16x16x32_bf16 v[72:75], a[112:115], a[64:67], 0
  ds_read_b64_tr_b16 a[168:169], v60 offset:32768
  s_waitcnt lgkmcnt(13)
  v_mfma_f32_16x16x32_bf16 v[72:75], a[116:119], a[68:71], v[72:75]
  ds_read_b64_tr_b16 a[170:171], v61 offset:32768
  v_exp_f32 v116, v116
  s_waitcnt lgkmcnt(12)
  v_mfma_f32_16x16x32_bf16 v[72:75], a[120:123], a[72:75], v[72:75]
  ds_read_b64_tr_b16 a[172:173], v62 offset:32768
  s_waitcnt lgkmcnt(11)
  v_mfma_f32_16x16x32_bf16 v[72:75], a[124:127], a[76:79], v[72:75]
  ds_read_b64_tr_b16 a[174:175], v63 offset:32768
  v_add_f32 v64, v64, v115
  v_mfma_f32_32x32x16_bf16 v[128:143], a[128:131], v[80:83], v[128:143]
  ds_read_b64_tr_b16 a[128:129], v48 offset:40960
  ds_read_b64_tr_b16 a[130:131], v48 offset:43008
  v_cvt_pk_bf16_f32 v89, v114, v115
  v_exp_f32 v117, v117
  v_add_f32 v64, v64, v116
  v_mfma_f32_32x32x16_bf16 v[144:159], a[132:135], v[80:83], v[144:159]
  ds_read_b64_tr_b16 a[132:133], v49 offset:40960
  ds_read_b64_tr_b16 a[134:135], v49 offset:43008
  buffer_load_dwordx4 v38, s[16:19], s36 offen offset:2048 nt lds
  v_exp_f32 v118, v118
  v_mfma_f32_32x32x16_bf16 v[160:175], a[136:139], v[80:83], v[160:175]
  ds_read_b64_tr_b16 a[136:137], v50 offset:40960
  ds_read_b64_tr_b16 a[138:139], v50 offset:43008
  v_add_f32 v64, v64, v117
  v_cvt_pk_bf16_f32 v90, v116, v117
  v_exp_f32 v119, v119
  v_mfma_f32_32x32x16_bf16 v[176:191], a[140:143], v[80:83], v[176:191]
  ds_read_b64_tr_b16 a[140:141], v51 offset:40960
  ds_read_b64_tr_b16 a[142:143], v51 offset:43008
  v_add_f32 v64, v64, v118
  v_exp_f32 v120, v120
  v_mfma_f32_32x32x16_bf16 v[128:143], a[144:147], v[84:87], v[128:143]
  ds_read_b64_tr_b16 a[144:145], v48 offset:45056
  ds_read_b64_tr_b16 a[146:147], v48 offset:47104
  v_add_f32 v64, v64, v119
  v_cvt_pk_bf16_f32 v91, v118, v119
  v_exp_f32 v121, v121
  v_mfma_f32_32x32x16_bf16 v[144:159], a[148:151], v[84:87], v[144:159]
  ds_read_b64_tr_b16 a[148:149], v49 offset:45056
  ds_read_b64_tr_b16 a[150:151], v49 offset:47104
  v_add_f32 v64, v64, v120
  v_exp_f32 v122, v122
  v_add_f32 v64, v64, v121
  v_mfma_f32_32x32x16_bf16 v[160:175], a[152:155], v[84:87], v[160:175]
  ds_read_b64_tr_b16 a[152:153], v50 offset:45056
  ds_read_b64_tr_b16 a[154:155], v50 offset:47104
  buffer_load_dwordx4 v39, s[16:19], s36 offen offset:3072 nt lds
  s_cmp_eq_u32 s34, 5
  v_cvt_pk_bf16_f32 v92, v120, v121
  v_mfma_f32_32x32x16_bf16 v[176:191], a[156:159], v[84:87], v[176:191]
  ds_read_b64_tr_b16 a[156:157], v51 offset:45056
  ds_read_b64_tr_b16 a[158:159], v51 offset:47104
  s_cselect_b32 s41, s96, s51
  v_exp_f32 v123, v123
  v_add_f32 v64, v64, v122
  v_exp_f32 v124, v124
  s_waitcnt lgkmcnt(15)
  v_mfma_f32_16x16x16_bf16 a[176:179], a[160:161], v[70:71], a[176:179]
  s_add_u32 s36, s36, s41
  v_add_f32 v64, v64, v123
  v_mfma_f32_16x16x16_bf16 a[180:183], a[162:163], v[70:71], a[180:183]
  v_cvt_pk_bf16_f32 v93, v122, v123
  v_mfma_f32_16x16x16_bf16 a[184:187], a[164:165], v[70:71], a[184:187]
  v_exp_f32 v125, v125
  v_add_f32 v64, v64, v124
  v_mfma_f32_16x16x16_bf16 a[188:191], a[166:167], v[70:71], a[188:191]
  v_exp_f32 v126, v126
  v_mfma_f32_16x16x16_bf16 a[192:195], a[168:169], v[70:71], a[192:195]
  v_add_f32 v64, v64, v125
  v_mfma_f32_16x16x16_bf16 a[196:199], a[170:171], v[70:71], a[196:199]
  v_cvt_pk_bf16_f32 v94, v124, v125
  v_exp_f32 v127, v127
  v_mfma_f32_16x16x16_bf16 a[200:203], a[172:173], v[70:71], a[200:203]
  v_add_f32 v64, v64, v126
  v_mfma_f32_16x16x16_bf16 a[204:207], a[174:175], v[70:71], a[204:207]
  v_add_f32 v64, v64, v127
  v_cvt_pk_bf16_f32 v95, v126, v127
  s_add_u32 s34, s34, 1
  s_branch K1_S0
K1_DRAIN:
  s_waitcnt lgkmcnt(0)
  v_mfma_f32_32x32x16_bf16 v[128:143], a[128:131], v[88:91], v[128:143]
  v_mfma_f32_32x32x16_bf16 v[144:159], a[132:135], v[88:91], v[144:159]
  v_mfma_f32_32x32x16_bf16 v[160:175], a[136:139], v[88:91], v[160:175]
  v_mfma_f32_32x32x16_bf16 v[176:191], a[140:143], v[88:91], v[176:191]
  v_mfma_f32_32x32x16_bf16 v[128:143], a[144:147], v[92:95], v[128:143]
  v_mfma_f32_32x32x16_bf16 v[144:159], a[148:151], v[92:95], v[144:159]
  v_mfma_f32_32x32x16_bf16 v[160:175], a[152:155], v[92:95], v[160:175]
  v_mfma_f32_32x32x16_bf16 v[176:191], a[156:159], v[92:95], v[176:191]
K1_EPI:
  s_cmp_eq_u32 s30, 0
  s_cbranch_scc0 K1_E_NN
  s_bitcmp1_b32 s95, 2
  s_cbranch_scc1 K1_E_NN
  s_cmp_eq_u32 s3, 0
  s_cbranch_scc0 OP_NGa
OP_NGLa:
  v_readfirstlane_b32 s97, v246
  s_nop 3
  s_cmp_lg_u32 s97, 0
  s_cbranch_scc1 OP_NGa
  s_sleep 8
  v_mov_b32 v246, 0
  global_load_dword v246, v246, s[100:101] sc1
  s_waitcnt vmcnt(0)
  s_branch OP_NGLa
OP_NGa:
K1_E_NN:
  s_and_b32 s41, s95, 5
  s_cselect_b32 s40, 0, s30
  s_cmp_eq_u32 s40, 1
  s_cbranch_scc0 K1_E_NOOP
  s_and_b32 s40, s2, 7
  s_lshr_b32 s41, s2, 3
  s_lshr_b32 s42, s41, 3
  s_lshl_b32 s42, s42, 2
  s_and_b32 s43, s41, 3
  s_add_u32 s42, s42, s43
  s_bitcmp1_b32 s41, 2
  s_cselect_b32 s43, 16, 0
  s_add_u32 s41, s42, s43
  s_mul_i32 s42, s41, 57
  s_lshr_b32 s42, s42, 9
  s_mul_i32 s43, s42, 9
  s_sub_u32 s61, s41, s43
  s_mul_i32 s44, s40, 3
  s_add_u32 s55, s44, s42
  s_mul_i32 s46, s55, 96
  s_add_u32 s47, s46, 95
  s_mul_i32 s46, s46, 29128
  s_lshr_b32 s46, s46, 22
  s_mul_i32 s47, s47, 29128
  s_lshr_b32 s47, s47, 22
  s_min_u32 s46, s46, 15
  s_min_u32 s47, s47, 15
  s_lshl_b32 s62, s46, 11
  s_lshl_b32 s67, s47, 11
  s_cmp_eq_u32 s3, 0
  s_cbranch_scc0 OP_PFa
  s_mov_b64 exec, 0xffffffff
  v_and_b32 v241, 15, v0
  v_lshlrev_b32 v241, 7, v241
  v_mov_b32 v240, s62
  v_mov_b32 v242, s67
  v_cmp_gt_u32 vcc, 16, v0
  s_nop 1
  v_cndmask_b32 v240, v242, v240, vcc
  v_add_u32 v240, v240, v241
  v_add_u32 v240, 19922944, v240
  global_load_dword v241, v240, s[20:21] sc1
  s_mov_b64 exec, -1
OP_PFa:
K1_E_NOOP:
  v_mov_b32 v1, v66
  v_mov_b32 v2, v64
  s_nop 1
  v_permlane16_swap_b32 v66, v1
  v_permlane32_swap_b32 v64, v2
  s_nop 1
  v_add_f32 v66, v66, v1
  v_add_f32 v64, v64, v2
  v_mov_b32 v1, v66
  v_rcp_f32 v11, v64
  s_nop 1
  v_permlane32_swap_b32 v66, v1
  s_nop 1
  v_add_f32 v66, v66, v1
  v_lshlrev_b32 v2, 4, v0
  s_lshl_b32 s41, s3, 13
  v_add_u32 v4, s41, v2
  v_lshlrev_b32 v5, 2, v0
  s_lshl_b32 s42, s3, 8
  v_add_u32 v6, s42, v5
  v_add_u32 v4, 115712, v4
  v_add_u32 v6, 148480, v6
  v_add_u32 v5, 148480, v5
  s_mov_b32 s44, 0x30800000
  s_mov_b32 s45, 0x4e800000
  s_mov_b32 s46, 0x4d800000
  v_cmp_nle_f32 vcc, s44, v64
  v_cmp_nge_f32 s[42:43], s45, v64
  v_cmp_nle_f32 s[48:49], s44, v66
  v_cmp_nge_f32 s[52:53], s46, v66
  s_nop 3
  s_or_b64 vcc, vcc, s[42:43]
  s_or_b64 s[48:49], s[48:49], s[52:53]
  s_or_b64 vcc, vcc, s[48:49]
  s_cbranch_scc0 K1_E_NOFAIL
  s_lshl_b32 s42, s30, 2
  s_add_u32 s42, s42, 158720
  v_mov_b32 v7, s42
  v_mov_b32 v9, 1
  ds_write_b32 v7, v9
K1_E_NOFAIL:
  ds_write_b128 v4, a[176:179] offset:0
  ds_write_b128 v4, a[180:183] offset:1024
  ds_write_b128 v4, a[184:187] offset:2048
  ds_write_b128 v4, a[188:191] offset:3072
  ds_write_b128 v4, a[192:195] offset:4096
  ds_write_b128 v4, a[196:199] offset:5120
  ds_write_b128 v4, a[200:203] offset:6144
  ds_write_b128 v4, a[204:207] offset:7168
  ds_write_b32 v6, v66
  s_mul_i32 s46, s28, 144
  s_lshl_b32 s47, s3, 5
  s_add_u32 s47, s46, s47
  v_and_b32 v7, 31, v0
  v_lshrrev_b32 v9, 5, v0
  v_add_u32 v12, s47, v7
  v_lshrrev_b32 v20, 5, v12
  v_lshlrev_b32 v20, 18, v20
  v_and_b32 v21, 31, v12
  v_lshl_add_u32 v21, v9, 5, v21
  v_lshl_add_u32 v16, v21, 4, v20
  s_lshl_b32 s64, s31, 13
  s_add_u32 s65, s64, 4096
  s_add_u32 s46, s46, 128
  v_and_b32 v7, 15, v0
  v_add_u32 v12, s46, v7
  v_lshrrev_b32 v20, 5, v12
  v_lshlrev_b32 v20, 18, v20
  v_and_b32 v21, 31, v12
  v_lshrrev_b32 v9, 4, v0
  v_and_b32 v13, 1, v9
  v_lshl_add_u32 v21, v13, 5, v21
  v_lshl_add_u32 v17, v21, 4, v20
  v_lshrrev_b32 v13, 1, v9
  v_lshl_add_u32 v17, v13, 3, v17
  s_lshl_b32 s47, s3, 11
  s_add_u32 s66, s64, s47
  s_or_b32 s40, s30, s60
  s_and_b32 s41, s95, 4
  s_or_b32 s40, s40, s41
  s_cmp_eq_u32 s40, 0
  s_cbranch_scc0 K1_E_IMM
  s_add_u32 s55, s31, 16
  s_lshl_b32 s33, s55, 8
  s_add_u32 s63, s33, 31744
  s_mov_b32 s32, 0
  s_mov_b32 s58, 17408
  s_mov_b32 s59, 34816
  s_add_u32 m0, s56, 107520
  s_nop 0
  buffer_load_dwordx4 v31, s[8:11], s33 offen lds
  v_mul_f32 v128, v11, v128
  v_mul_f32 v129, v11, v129
  v_mul_f32 v130, v11, v130
  v_mul_f32 v131, v11, v131
  v_mul_f32 v132, v11, v132
  v_mul_f32 v133, v11, v133
  v_mul_f32 v134, v11, v134
  v_mul_f32 v135, v11, v135
  v_cvt_pk_bf16_f32 v80, v128, v129
  v_cvt_pk_bf16_f32 v81, v130, v131
  v_cvt_pk_bf16_f32 v82, v132, v133
  v_cvt_pk_bf16_f32 v83, v134, v135
  buffer_load_dwordx4 v31, s[8:11], s63 offen offset:1024 lds
  s_add_u32 m0, s57, 98304
  s_add_u32 s33, s33, 262144
  s_add_u32 s63, s63, 262144
  v_mul_f32 v136, v11, v136
  v_mul_f32 v137, v11, v137
  v_mul_f32 v138, v11, v138
  v_mul_f32 v139, v11, v139
  v_mul_f32 v140, v11, v140
  v_mul_f32 v141, v11, v141
  v_mul_f32 v142, v11, v142
  v_mul_f32 v143, v11, v143
  v_cvt_pk_bf16_f32 v84, v136, v137
  v_cvt_pk_bf16_f32 v85, v138, v139
  v_cvt_pk_bf16_f32 v86, v140, v141
  v_cvt_pk_bf16_f32 v87, v142, v143
  buffer_load_dwordx4 v30, s[4:7], s32 offen offset:0 lds
  s_add_u32 s32, s32, 64
  v_mul_f32 v144, v11, v144
  v_mul_f32 v145, v11, v145
  v_mul_f32 v146, v11, v146
  v_mul_f32 v147, v11, v147
  v_mul_f32 v148, v11, v148
  v_mul_f32 v149, v11, v149
  v_mul_f32 v150, v11, v150
  v_mul_f32 v151, v11, v151
  v_cvt_pk_bf16_f32 v88, v144, v145
  v_cvt_pk_bf16_f32 v89, v146, v147
  v_cvt_pk_bf16_f32 v90, v148, v149
  v_cvt_pk_bf16_f32 v91, v150, v151
  buffer_load_dwordx4 v30, s[4:7], s58 offen offset:1024 lds
  s_add_u32 s58, s58, 64
  v_mul_f32 v152, v11, v152
  v_mul_f32 v153, v11, v153
  v_mul_f32 v154, v11, v154
  v_mul_f32 v155, v11, v155
  v_mul_f32 v156, v11, v156
  v_mul_f32 v157, v11, v157
  v_mul_f32 v158, v11, v158
  v_mul_f32 v159, v11, v159
  v_cvt_pk_bf16_f32 v92, v152, v153
  v_cvt_pk_bf16_f32 v93, v154, v155
  v_cvt_pk_bf16_f32 v94, v156, v157
  v_cvt_pk_bf16_f32 v95, v158, v159
  s_mov_b64 exec, 0xffff
  buffer_load_dwordx4 v30, s[4:7], s59 offen offset:2048 lds
  s_mov_b64 exec, -1
  s_add_u32 s59, s59, 64
  v_mul_f32 v160, v11, v160
  v_mul_f32 v161, v11, v161
  v_mul_f32 v162, v11, v162
  v_mul_f32 v163, v11, v163
  v_mul_f32 v164, v11, v164
  v_mul_f32 v165, v11, v165
  v_mul_f32 v166, v11, v166
  v_mul_f32 v167, v11, v167
  v_cvt_pk_bf16_f32 v96, v160, v161
  v_cvt_pk_bf16_f32 v97, v162, v163
  v_cvt_pk_bf16_f32 v98, v164, v165
  v_cvt_pk_bf16_f32 v99, v166, v167
  v_mul_f32 v168, v11, v168
  v_mul_f32 v169, v11, v169
  v_mul_f32 v170, v11, v170
  v_mul_f32 v171, v11, v171
  v_mul_f32 v172, v11, v172
  v_mul_f32 v173, v11, v173
  v_mul_f32 v174, v11, v174
  v_mul_f32 v175, v11, v175
  v_cvt_pk_bf16_f32 v100, v168, v169
  v_cvt_pk_bf16_f32 v101, v170, v171
  v_cvt_pk_bf16_f32 v102, v172, v173
  v_cvt_pk_bf16_f32 v103, v174, v175
  v_mul_f32 v176, v11, v176
  v_mul_f32 v177, v11, v177
  v_mul_f32 v178, v11, v178
  v_mul_f32 v179, v11, v179
  v_mul_f32 v180, v11, v180
  v_mul_f32 v181, v11, v181
  v_mul_f32 v182, v11, v182
  v_mul_f32 v183, v11, v183
  v_cvt_pk_bf16_f32 v104, v176, v177
  v_cvt_pk_bf16_f32 v105, v178, v179
  v_cvt_pk_bf16_f32 v106, v180, v181
  v_cvt_pk_bf16_f32 v107, v182, v183
  v_mul_f32 v184, v11, v184
  v_mul_f32 v185, v11, v185
  v_mul_f32 v186, v11, v186
  v_mul_f32 v187, v11, v187
  v_mul_f32 v188, v11, v188
  v_mul_f32 v189, v11, v189
  v_mul_f32 v190, v11, v190
  v_mul_f32 v191, v11, v191
  v_cvt_pk_bf16_f32 v108, v184, v185
  v_cvt_pk_bf16_f32 v109, v186, v187
  v_cvt_pk_bf16_f32 v110, v188, v189
  v_cvt_pk_bf16_f32 v111, v190, v191
  s_branch K1_E_GO
K1_E_IMM:
  v_mul_f32 v128, v11, v128
  v_mul_f32 v129, v11, v129
  v_mul_f32 v130, v11, v130
  v_mul_f32 v131, v11, v131
  v_mul_f32 v132, v11, v132
  v_mul_f32 v133, v11, v133
  v_mul_f32 v134, v11, v134
  v_mul_f32 v135, v11, v135
  v_cvt_pk_bf16_f32 v80, v128, v129
  v_cvt_pk_bf16_f32 v81, v130, v131
  v_cvt_pk_bf16_f32 v82, v132, v133
  v_cvt_pk_bf16_f32 v83, v134, v135
  v_mul_f32 v136, v11, v136
  v_mul_f32 v137, v11, v137
  v_mul_f32 v138, v11, v138
  v_mul_f32 v139, v11, v139
  v_mul_f32 v140, v11, v140
  v_mul_f32 v141, v11, v141
  v_mul_f32 v142, v11, v142
  v_mul_f32 v143, v11, v143
  v_cvt_pk_bf16_f32 v84, v136, v137
  v_cvt_pk_bf16_f32 v85, v138, v139
  v_cvt_pk_bf16_f32 v86, v140, v141
  v_cvt_pk_bf16_f32 v87, v142, v143
  buffer_store_dwordx4 v[80:83], v16, s[20:23], s64 offen offset:0 sc1
  v_mul_f32 v144, v11, v144
  v_mul_f32 v145, v11, v145
  v_mul_f32 v146, v11, v146
  v_mul_f32 v147, v11, v147
  v_mul_f32 v148, v11, v148
  v_mul_f32 v149, v11, v149
  v_mul_f32 v150, v11, v150
  v_mul_f32 v151, v11, v151
  v_cvt_pk_bf16_f32 v88, v144, v145
  v_cvt_pk_bf16_f32 v89, v146, v147
  v_cvt_pk_bf16_f32 v90, v148, v149
  v_cvt_pk_bf16_f32 v91, v150, v151
  buffer_store_dwordx4 v[84:87], v16, s[20:23], s64 offen offset:1024 sc1
  v_mul_f32 v152, v11, v152
  v_mul_f32 v153, v11, v153
  v_mul_f32 v154, v11, v154
  v_mul_f32 v155, v11, v155
  v_mul_f32 v156, v11, v156
  v_mul_f32 v157, v11, v157
  v_mul_f32 v158, v11, v158
  v_mul_f32 v159, v11, v159
  v_cvt_pk_bf16_f32 v92, v152, v153
  v_cvt_pk_bf16_f32 v93, v154, v155
  v_cvt_pk_bf16_f32 v94, v156, v157
  v_cvt_pk_bf16_f32 v95, v158, v159
  buffer_store_dwordx4 v[88:91], v16, s[20:23], s64 offen offset:2048 sc1
  v_mul_f32 v160, v11, v160
  v_mul_f32 v161, v11, v161
  v_mul_f32 v162, v11, v162
  v_mul_f32 v163, v11, v163
  v_mul_f32 v164, v11, v164
  v_mul_f32 v165, v11, v165
  v_mul_f32 v166, v11, v166
  v_mul_f32 v167, v11, v167
  v_cvt_pk_bf16_f32 v96, v160, v161
  v_cvt_pk_bf16_f32 v97, v162, v163
  v_cvt_pk_bf16_f32 v98, v164, v165
  v_cvt_pk_bf16_f32 v99, v166, v167
  buffer_store_dwordx4 v[92:95], v16, s[20:23], s64 offen offset:3072 sc1
  v_mul_f32 v168, v11, v168
  v_mul_f32 v169, v11, v169
  v_mul_f32 v170, v11, v170
  v_mul_f32 v171, v11, v171
  v_mul_f32 v172, v11, v172
  v_mul_f32 v173, v11, v173
  v_mul_f32 v174, v11, v174
  v_mul_f32 v175, v11, v175
  v_cvt_pk_bf16_f32 v100, v168, v169
  v_cvt_pk_bf16_f32 v101, v170, v171
  v_cvt_pk_bf16_f32 v102, v172, v173
  v_cvt_pk_bf16_f32 v103, v174, v175
  buffer_store_dwordx4 v[96:99], v16, s[20:23], s65 offen offset:0 sc1
  v_mul_f32 v176, v11, v176
  v_mul_f32 v177, v11, v177
  v_mul_f32 v178, v11, v178
  v_mul_f32 v179, v11, v179
  v_mul_f32 v180, v11, v180
  v_mul_f32 v181, v11, v181
  v_mul_f32 v182, v11, v182
  v_mul_f32 v183, v11, v183
  v_cvt_pk_bf16_f32 v104, v176, v177
  v_cvt_pk_bf16_f32 v105, v178, v179
  v_cvt_pk_bf16_f32 v106, v180, v181
  v_cvt_pk_bf16_f32 v107, v182, v183
  buffer_store_dwordx4 v[100:103], v16, s[20:23], s65 offen offset:1024 sc1
  v_mul_f32 v184, v11, v184
  v_mul_f32 v185, v11, v185
  v_mul_f32 v186, v11, v186
  v_mul_f32 v187, v11, v187
  v_mul_f32 v188, v11, v188
  v_mul_f32 v189, v11, v189
  v_mul_f32 v190, v11, v190
  v_mul_f32 v191, v11, v191
  v_cvt_pk_bf16_f32 v108, v184, v185
  v_cvt_pk_bf16_f32 v109, v186, v187
  v_cvt_pk_bf16_f32 v110, v188, v189
  v_cvt_pk_bf16_f32 v111, v190, v191
  buffer_store_dwordx4 v[104:107], v16, s[20:23], s65 offen offset:2048 sc1
  buffer_store_dwordx4 v[108:111], v16, s[20:23], s65 offen offset:3072 sc1
K1_E_GO:
  s_and_b32 s41, s95, 5
  s_cselect_b32 s40, 0, s30
  s_cmp_eq_u32 s40, 1
  s_cbranch_scc0 K1_E_NOOP2
  s_cmp_eq_u32 s3, 0
  s_cbranch_scc0 OP_OK0
  s_waitcnt vmcnt(8)
OP_CHK0:
  s_mov_b64 exec, 0xffffffff
  v_cmp_ne_u32 vcc, s97, v241
  s_mov_b64 exec, -1
  s_nop 3
  s_cmp_eq_u32 vcc_lo, 0
  s_cbranch_scc1 OP_OK0
  s_sleep 8
  s_mov_b64 exec, 0xffffffff
  v_and_b32 v241, 15, v0
  v_lshlrev_b32 v241, 7, v241
  v_mov_b32 v240, s62
  v_mov_b32 v242, s67
  v_cmp_gt_u32 vcc, 16, v0
  s_nop 1
  v_cndmask_b32 v240, v242, v240, vcc
  v_add_u32 v240, v240, v241
  v_add_u32 v240, 19922944, v240
  global_load_dword v241, v240, s[20:21] sc1
  s_mov_b64 exec, -1
  s_waitcnt vmcnt(0)
  s_branch OP_CHK0
OP_OK0:
K1_E_NOOP2:
  s_waitcnt lgkmcnt(0)
  s_barrier
  s_lshl_b32 s43, s3, 11
  v_add_u32 v4, s43, v2
  v_add_u32 v4, 115712, v4
  v_lshlrev_b32 v5, 2, v0
  v_add_u32 v5, 148480, v5
  s_lshl_b32 s42, s30, 2
  s_add_u32 s42, s42, 158720
  v_mov_b32 v7, s42
  ds_read_b32 v7, v7
  ds_read_b32 v12, v5 offset:0
  ds_read_b32 v13, v5 offset:256
  ds_read_b32 v14, v5 offset:512
  ds_read_b32 v15, v5 offset:768
  ds_read_b128 v[128:131], v4 offset:0
  ds_read_b128 v[132:135], v4 offset:1024
  ds_read_b128 v[136:139], v4 offset:8192
  ds_read_b128 v[140:143], v4 offset:9216
  ds_read_b128 v[144:147], v4 offset:16384
  ds_read_b128 v[148:151], v4 offset:17408
  ds_read_b128 v[152:155], v4 offset:24576
  ds_read_b128 v[156:159], v4 offset:25600
  s_waitcnt lgkmcnt(8)
  v_readfirstlane_b32 s42, v7
  s_bitcmp1_b32 s95, 2
  s_cselect_b32 s42, 0, s42
  s_lshl_b32 s42, s42, s30
  s_or_b32 s95, s95, s42
  v_add_f32 v12, v12, v13
  v_add_f32 v14, v14, v15
  v_add_f32 v12, v12, v14
  v_rcp_f32 v19, v12
  s_waitcnt lgkmcnt(0)
  v_add_f32 v128, v128, v136
  v_add_f32 v144, v144, v152
  v_add_f32 v128, v128, v144
  v_mul_f32 v128, v19, v128
  v_add_f32 v129, v129, v137
  v_add_f32 v145, v145, v153
  v_add_f32 v129, v129, v145
  v_mul_f32 v129, v19, v129
  v_add_f32 v130, v130, v138
  v_add_f32 v146, v146, v154
  v_add_f32 v130, v130, v146
  v_mul_f32 v130, v19, v130
  v_add_f32 v131, v131, v139
  v_add_f32 v147, v147, v155
  v_add_f32 v131, v131, v147
  v_mul_f32 v131, v19, v131
  v_cvt_pk_bf16_f32 v112, v128, v129
  v_cvt_pk_bf16_f32 v113, v130, v131
  v_add_f32 v132, v132, v140
  v_add_f32 v148, v148, v156
  v_add_f32 v132, v132, v148
  v_mul_f32 v132, v19, v132
  v_add_f32 v133, v133, v141
  v_add_f32 v149, v149, v157
  v_add_f32 v133, v133, v149
  v_mul_f32 v133, v19, v133
  v_add_f32 v134, v134, v142
  v_add_f32 v150, v150, v158
  v_add_f32 v134, v134, v150
  v_mul_f32 v134, v19, v134
  v_add_f32 v135, v135, v143
  v_add_f32 v151, v151, v159
  v_add_f32 v135, v135, v151
  v_mul_f32 v135, v19, v135
  v_cvt_pk_bf16_f32 v114, v132, v133
  v_cvt_pk_bf16_f32 v115, v134, v135
  s_or_b32 s40, s30, s60
  s_and_b32 s41, s95, 4
  s_or_b32 s40, s40, s41
  s_cmp_eq_u32 s40, 0
  s_cbranch_scc1 K1_E_DEF
  buffer_store_dwordx2 v[112:113], v17, s[20:23], s66 offen offset:0 sc1
  buffer_store_dwordx2 v[114:115], v17, s[20:23], s66 offen offset:1024 sc1
  s_branch K1_E_END
K1_E_DEF:
  s_barrier
  s_add_u32 m0, s56, 124928
  s_nop 0
  buffer_load_dwordx4 v31, s[8:11], s33 offen lds
  buffer_load_dwordx4 v31, s[8:11], s63 offen offset:1024 lds
  s_add_u32 m0, s57, 115712
  s_add_u32 s33, s33, 262144
  s_add_u32 s63, s63, 262144
  buffer_load_dwordx4 v30, s[4:7], s32 offen offset:0 lds
  s_add_u32 s32, s32, 64
  buffer_load_dwordx4 v30, s[4:7], s58 offen offset:1024 lds
  s_add_u32 s58, s58, 64
  s_mov_b64 exec, 0xffff
  buffer_load_dwordx4 v30, s[4:7], s59 offen offset:2048 lds
  s_mov_b64 exec, -1
  s_add_u32 s59, s59, 64
  s_add_u32 m0, s56, 142336
  s_nop 0
  buffer_load_dwordx4 v31, s[8:11], s33 offen lds
  buffer_load_dwordx4 v31, s[8:11], s63 offen offset:1024 lds
  s_add_u32 m0, s57, 133120
  s_add_u32 s33, s33, 262144
  s_add_u32 s63, s63, 262144
  buffer_load_dwordx4 v30, s[4:7], s32 offen offset:0 lds
  s_add_u32 s32, s32, 64
  buffer_load_dwordx4 v30, s[4:7], s58 offen offset:1024 lds
  s_add_u32 s58, s58, 64
  s_mov_b64 exec, 0xffff
  buffer_load_dwordx4 v30, s[4:7], s59 offen offset:2048 lds
  s_mov_b64 exec, -1
  s_add_u32 s59, s59, 64
K1_E_END:
  s_bitcmp1_b32 s95, 2
  s_cbranch_scc1 K1_SLOW_NEXT
  s_add_u32 s30, s30, 1
  s_add_u32 s31, s31, 16
  s_cmp_lt_u32 s30, 2
  s_cbranch_scc0 K1_FIN
  s_mov_b32 s67, 2
  s_lshl_b32 s37, s31, 17
  s_add_u32 s37, s37, s38
  s_cmp_eq_u32 s60, 0
  s_cbranch_scc1 K1_Q
  v_accvgpr_read_b32 v192, a32
  v_accvgpr_read_b32 v193, a33
  v_accvgpr_read_b32 v194, a34
  v_accvgpr_read_b32 v195, a35
  v_accvgpr_read_b32 v196, a36
  v_accvgpr_read_b32 v197, a37
  v_accvgpr_read_b32 v198, a38
  v_accvgpr_read_b32 v199, a39
  v_accvgpr_read_b32 v200, a40
  v_accvgpr_read_b32 v201, a41
  v_accvgpr_read_b32 v202, a42
  v_accvgpr_read_b32 v203, a43
  v_accvgpr_read_b32 v204, a44
  v_accvgpr_read_b32 v205, a45
  v_accvgpr_read_b32 v206, a46
  v_accvgpr_read_b32 v207, a47
  v_accvgpr_read_b32 v208, a48
  v_accvgpr_read_b32 v209, a49
  v_accvgpr_read_b32 v210, a50
  v_accvgpr_read_b32 v211, a51
  v_accvgpr_read_b32 v212, a52
  v_accvgpr_read_b32 v213, a53
  v_accvgpr_read_b32 v214, a54
  v_accvgpr_read_b32 v215, a55
  v_accvgpr_read_b32 v216, a56
  v_accvgpr_read_b32 v217, a57
  v_accvgpr_read_b32 v218, a58
  v_accvgpr_read_b32 v219, a59
  v_accvgpr_read_b32 v220, a60
  v_accvgpr_read_b32 v221, a61
  v_accvgpr_read_b32 v222, a62
  v_accvgpr_read_b32 v223, a63
  s_add_u32 s62, s62, 4096
  s_mov_b32 s61, 4
  s_branch K1_TPRE
K1_FIN:
  s_and_b32 s40, s95, 3
  s_cbranch_scc1 K1_SLOW_NEXT
K1_FIN2:
  s_lshr_b32 s41, s2, 3
  s_lshr_b32 s42, s41, 3
  s_lshl_b32 s42, s42, 2
  s_and_b32 s43, s41, 3
  s_add_u32 s42, s42, s43
  s_bitcmp1_b32 s41, 2
  s_cselect_b32 s43, 16, 0
  s_add_u32 s41, s42, s43
  s_cmp_ge_u32 s41, 27
  s_cbranch_scc1 K1_NOTILE
  s_load_dwordx2 s[12:13], s[0:1], 40
  s_mul_i32 s45, s55, 768
  s_add_u32 s45, s45, s3
  s_lshl_b32 s32, s45, 10
  s_mul_i32 s45, s3, 18432
  s_lshl_b32 s46, s61, 7
  s_add_u32 s33, s45, s46
  s_lshl_b32 s34, s3, 14
  v_lshlrev_b32 v2, 4, v0
  v_add_u32 v3, 0x40000, v2
  v_add_u32 v4, 0x80000, v2
  v_lshrrev_b32 v8, 3, v0
  v_mul_u32_u24 v8, 1152, v8
  v_lshrrev_b32 v9, 4, v0
  v_and_b32 v9, 1, v9
  v_lshlrev_b32 v9, 2, v9
  v_and_b32 v10, 7, v0
  v_xor_b32 v9, v9, v10
  v_lshl_add_u32 v5, v9, 4, v8
  v_add_u32 v6, 8192, v5
  buffer_load_dwordx4 v[16:19], v2, s[20:23], s32 offen sc1
  buffer_load_dwordx4 v[20:23], v3, s[20:23], s32 offen sc1
  buffer_load_dwordx4 v[24:27], v4, s[20:23], s32 offen sc1
  s_add_u32 m0, s34, 0
  s_add_u32 s32, s32, 4096
  buffer_load_dwordx4 v5, s[24:27], s33 offen lds
  buffer_load_dwordx4 v6, s[24:27], s33 offen offset:1024 lds
  s_add_u32 s33, s33, 73728
  buffer_load_dwordx4 v[28:31], v2, s[20:23], s32 offen sc1
  buffer_load_dwordx4 v[32:35], v3, s[20:23], s32 offen sc1
  buffer_load_dwordx4 v[36:39], v4, s[20:23], s32 offen sc1
  s_add_u32 m0, s34, 2048
  s_add_u32 s32, s32, 4096
  buffer_load_dwordx4 v5, s[24:27], s33 offen lds
  buffer_load_dwordx4 v6, s[24:27], s33 offen offset:1024 lds
  s_add_u32 s33, s33, 73728
  buffer_load_dwordx4 v[40:43], v2, s[20:23], s32 offen sc1
  buffer_load_dwordx4 v[44:47], v3, s[20:23], s32 offen sc1
  buffer_load_dwordx4 v[48:51], v4, s[20:23], s32 offen sc1
  s_add_u32 m0, s34, 4096
  s_add_u32 s32, s32, 4096
  buffer_load_dwordx4 v5, s[24:27], s33 offen lds
  buffer_load_dwordx4 v6, s[24:27], s33 offen offset:1024 lds
  s_add_u32 s33, s33, 73728
  buffer_load_dwordx4 v[52:55], v2, s[20:23], s32 offen sc1
  buffer_load_dwordx4 v[56:59], v3, s[20:23], s32 offen sc1
  buffer_load_dwordx4 v[60:63], v4, s[20:23], s32 offen sc1
  s_add_u32 m0, s34, 6144
  s_add_u32 s32, s32, 4096
  buffer_load_dwordx4 v5, s[24:27], s33 offen lds
  buffer_load_dwordx4 v6, s[24:27], s33 offen offset:1024 lds
  s_add_u32 s33, s33, 73728
  buffer_load_dwordx4 v[64:67], v2, s[20:23], s32 offen sc1
  buffer_load_dwordx4 v[68:71], v3, s[20:23], s32 offen sc1
  buffer_load_dwordx4 v[72:75], v4, s[20:23], s32 offen sc1
  s_add_u32 m0, s34, 8192
  s_add_u32 s32, s32, 4096
  buffer_load_dwordx4 v5, s[24:27], s33 offen lds
  buffer_load_dwordx4 v6, s[24:27], s33 offen offset:1024 lds
  s_add_u32 s33, s33, 73728
  buffer_load_dwordx4 v[76:79], v2, s[20:23], s32 offen sc1
  buffer_load_dwordx4 v[80:83], v3, s[20:23], s32 offen sc1
  buffer_load_dwordx4 v[84:87], v4, s[20:23], s32 offen sc1
  s_add_u32 m0, s34, 10240
  s_add_u32 s32, s32, 4096
  buffer_load_dwordx4 v5, s[24:27], s33 offen lds
  buffer_load_dwordx4 v6, s[24:27], s33 offen offset:1024 lds
  s_add_u32 s33, s33, 73728
  buffer_load_dwordx4 v[88:91], v2, s[20:23], s32 offen sc1
  buffer_load_dwordx4 v[92:95], v3, s[20:23], s32 offen sc1
  buffer_load_dwordx4 v[96:99], v4, s[20:23], s32 offen sc1
  s_add_u32 m0, s34, 12288
  s_add_u32 s32, s32, 4096
  buffer_load_dwordx4 v5, s[24:27], s33 offen lds
  buffer_load_dwordx4 v6, s[24:27], s33 offen offset:1024 lds
  s_add_u32 s33, s33, 73728
  v_and_b32 v9, 15, v0
  v_lshrrev_b32 v9, 2, v9
  v_lshrrev_b32 v10, 5, v0
  v_lshl_add_u32 v11, v10, 2, v9
  v_lshlrev_b32 v11, 7, v11
  v_add_u32 v11, s34, v11
  v_lshrrev_b32 v12, 4, v0
  v_and_b32 v12, 1, v12
  v_and_b32 v13, 3, v0
  v_lshrrev_b32 v14, 1, v13
  v_lshl_add_u32 v12, v12, 1, v14
  v_lshrrev_b32 v14, 1, v9
  v_lshlrev_b32 v14, 2, v14
  v_xor_b32 v12, v12, v14
  v_lshl_add_u32 v11, v12, 4, v11
  v_and_b32 v13, 1, v13
  v_lshl_add_u32 v7, v13, 3, v11
  v_xor_b32 v8, 64, v7
  v_mov_b32 v12, 0
  v_mov_b32 v13, 0
  v_mov_b32 v14, 0
  v_mov_b32 v15, 0
  s_nop 1
  v_mfma_f32_32x32x16_bf16 v[128:143], v[12:15], v[12:15], 0
  v_mfma_f32_32x32x16_bf16 v[144:159], v[12:15], v[12:15], 0
  v_mfma_f32_32x32x16_bf16 v[160:175], v[12:15], v[12:15], 0
  v_mfma_f32_32x32x16_bf16 v[176:191], v[12:15], v[12:15], 0
  v_mfma_f32_32x32x16_bf16 v[192:207], v[12:15], v[12:15], 0
  v_mfma_f32_32x32x16_bf16 v[208:223], v[12:15], v[12:15], 0
  s_waitcnt vmcnt(35)
  s_barrier
  s_cmp_eq_u32 s3, 0
  s_cbranch_scc0 K1_SIGb
  s_lshl_b32 s40, s28, 4
  s_add_u32 s40, s40, s29
  s_lshl_b32 s40, s40, 7
  s_add_u32 s40, s40, 19955712
  v_mov_b32 v242, s40
  v_mov_b32 v243, s97
  s_mov_b64 exec, 1
  global_store_dword v242, v243, s[20:21] sc1
  s_mov_b64 exec, -1
K1_SIGb:
  s_waitcnt vmcnt(30)
  ds_read_b64_tr_b16 v[112:113], v7 offset:0
  ds_read_b64_tr_b16 v[114:115], v7 offset:1024
  ds_read_b64_tr_b16 v[116:117], v8 offset:0
  ds_read_b64_tr_b16 v[118:119], v8 offset:1024
  s_mov_b32 s35, 0
OP_LOOP:
  s_cmp_eq_u32 s35, 2
  s_cbranch_scc0 OP_NP2
  s_cmp_eq_u32 s3, 0
  s_cbranch_scc0 OP_PFb
  s_mov_b64 exec, 0xffffffff
  v_and_b32 v241, 15, v0
  v_lshlrev_b32 v241, 7, v241
  v_mov_b32 v240, s62
  v_mov_b32 v242, s67
  v_cmp_gt_u32 vcc, 16, v0
  s_nop 1
  v_cndmask_b32 v240, v242, v240, vcc
  v_add_u32 v240, v240, v241
  v_add_u32 v240, 19955712, v240
  global_load_dword v241, v240, s[20:21] sc1
  s_mov_b64 exec, -1
OP_PFb:
OP_NP2:
  s_cmp_eq_u32 s35, 3
  s_cbranch_scc0 OP_NP3
  s_cmp_eq_u32 s3, 0
  s_cbranch_scc0 OP_OK1
OP_CHK1:
  s_mov_b64 exec, 0xffffffff
  v_cmp_ne_u32 vcc, s97, v241
  s_mov_b64 exec, -1
  s_nop 3
  s_cmp_eq_u32 vcc_lo, 0
  s_cbranch_scc1 OP_OK1
  s_sleep 8
  s_mov_b64 exec, 0xffffffff
  v_and_b32 v241, 15, v0
  v_lshlrev_b32 v241, 7, v241
  v_mov_b32 v240, s62
  v_mov_b32 v242, s67
  v_cmp_gt_u32 vcc, 16, v0
  s_nop 1
  v_cndmask_b32 v240, v242, v240, vcc
  v_add_u32 v240, v240, v241
  v_add_u32 v240, 19955712, v240
  global_load_dword v241, v240, s[20:21] sc1
  s_mov_b64 exec, -1
  s_waitcnt vmcnt(0)
  s_branch OP_CHK1
OP_OK1:
  s_barrier
OP_NP3:
  s_waitcnt vmcnt(25)
  s_waitcnt lgkmcnt(0)
  s_add_u32 m0, s34, 14336
  v_mfma_f32_32x32x16_bf16 v[128:143], v[112:115], v[16:19], v[128:143]
  buffer_load_dwordx4 v[100:103], v2, s[20:23], s32 offen sc1
  ds_read_b64_tr_b16 v[120:121], v7 offset:2048
  ds_read_b64_tr_b16 v[122:123], v7 offset:3072
  v_mfma_f32_32x32x16_bf16 v[144:159], v[112:115], v[20:23], v[144:159]
  ds_read_b64_tr_b16 v[124:125], v8 offset:2048
  ds_read_b64_tr_b16 v[126:127], v8 offset:3072
  buffer_load_dwordx4 v5, s[24:27], s33 offen lds
  v_mfma_f32_32x32x16_bf16 v[160:175], v[112:115], v[24:27], v[160:175]
  v_mfma_f32_32x32x16_bf16 v[176:191], v[116:119], v[16:19], v[176:191]
  buffer_load_dwordx4 v[104:107], v3, s[20:23], s32 offen sc1
  v_mfma_f32_32x32x16_bf16 v[192:207], v[116:119], v[20:23], v[192:207]
  buffer_load_dwordx4 v6, s[24:27], s33 offen offset:1024 lds
  s_add_u32 s33, s33, 73728
  v_mfma_f32_32x32x16_bf16 v[208:223], v[116:119], v[24:27], v[208:223]
  buffer_load_dwordx4 v[108:111], v4, s[20:23], s32 offen sc1
  s_add_u32 s32, s32, 4096
  s_waitcnt vmcnt(25)
  s_waitcnt lgkmcnt(0)
  s_add_u32 m0, s34, 0
  v_mfma_f32_32x32x16_bf16 v[128:143], v[120:123], v[28:31], v[128:143]
  buffer_load_dwordx4 v[16:19], v2, s[20:23], s32 offen sc1
  ds_read_b64_tr_b16 v[112:113], v7 offset:4096
  ds_read_b64_tr_b16 v[114:115], v7 offset:5120
  v_mfma_f32_32x32x16_bf16 v[144:159], v[120:123], v[32:35], v[144:159]
  ds_read_b64_tr_b16 v[116:117], v8 offset:4096
  ds_read_b64_tr_b16 v[118:119], v8 offset:5120
  buffer_load_dwordx4 v5, s[24:27], s33 offen lds
  v_mfma_f32_32x32x16_bf16 v[160:175], v[120:123], v[36:39], v[160:175]
  v_mfma_f32_32x32x16_bf16 v[176:191], v[124:127], v[28:31], v[176:191]
  buffer_load_dwordx4 v[20:23], v3, s[20:23], s32 offen sc1
  v_mfma_f32_32x32x16_bf16 v[192:207], v[124:127], v[32:35], v[192:207]
  buffer_load_dwordx4 v6, s[24:27], s33 offen offset:1024 lds
  s_add_u32 s33, s33, 73728
  v_mfma_f32_32x32x16_bf16 v[208:223], v[124:127], v[36:39], v[208:223]
  buffer_load_dwordx4 v[24:27], v4, s[20:23], s32 offen sc1
  s_add_u32 s32, s32, 4096
  s_waitcnt vmcnt(25)
  s_waitcnt lgkmcnt(0)
  s_add_u32 m0, s34, 2048
  v_mfma_f32_32x32x16_bf16 v[128:143], v[112:115], v[40:43], v[128:143]
  buffer_load_dwordx4 v[28:31], v2, s[20:23], s32 offen sc1
  ds_read_b64_tr_b16 v[120:121], v7 offset:6144
  ds_read_b64_tr_b16 v[122:123], v7 offset:7168
  v_mfma_f32_32x32x16_bf16 v[144:159], v[112:115], v[44:47], v[144:159]
  ds_read_b64_tr_b16 v[124:125], v8 offset:6144
  ds_read_b64_tr_b16 v[126:127], v8 offset:7168
  buffer_load_dwordx4 v5, s[24:27], s33 offen lds
  v_mfma_f32_32x32x16_bf16 v[160:175], v[112:115], v[48:51], v[160:175]
  v_mfma_f32_32x32x16_bf16 v[176:191], v[116:119], v[40:43], v[176:191]
  buffer_load_dwordx4 v[32:35], v3, s[20:23], s32 offen sc1
  v_mfma_f32_32x32x16_bf16 v[192:207], v[116:119], v[44:47], v[192:207]
  buffer_load_dwordx4 v6, s[24:27], s33 offen offset:1024 lds
  s_add_u32 s33, s33, 73728
  v_mfma_f32_32x32x16_bf16 v[208:223], v[116:119], v[48:51], v[208:223]
  buffer_load_dwordx4 v[36:39], v4, s[20:23], s32 offen sc1
  s_add_u32 s32, s32, 4096
  s_waitcnt vmcnt(25)
  s_waitcnt lgkmcnt(0)
  s_add_u32 m0, s34, 4096
  v_mfma_f32_32x32x16_bf16 v[128:143], v[120:123], v[52:55], v[128:143]
  buffer_load_dwordx4 v[40:43], v2, s[20:23], s32 offen sc1
  ds_read_b64_tr_b16 v[112:113], v7 offset:8192
  ds_read_b64_tr_b16 v[114:115], v7 offset:9216
  v_mfma_f32_32x32x16_bf16 v[144:159], v[120:123], v[56:59], v[144:159]
  ds_read_b64_tr_b16 v[116:117], v8 offset:8192
  ds_read_b64_tr_b16 v[118:119], v8 offset:9216
  buffer_load_dwordx4 v5, s[24:27], s33 offen lds
  v_mfma_f32_32x32x16_bf16 v[160:175], v[120:123], v[60:63], v[160:175]
  v_mfma_f32_32x32x16_bf16 v[176:191], v[124:127], v[52:55], v[176:191]
  buffer_load_dwordx4 v[44:47], v3, s[20:23], s32 offen sc1
  v_mfma_f32_32x32x16_bf16 v[192:207], v[124:127], v[56:59], v[192:207]
  buffer_load_dwordx4 v6, s[24:27], s33 offen offset:1024 lds
  s_add_u32 s33, s33, 73728
  v_mfma_f32_32x32x16_bf16 v[208:223], v[124:127], v[60:63], v[208:223]
  buffer_load_dwordx4 v[48:51], v4, s[20:23], s32 offen sc1
  s_add_u32 s32, s32, 4096
  s_waitcnt vmcnt(25)
  s_waitcnt lgkmcnt(0)
  s_add_u32 m0, s34, 6144
  v_mfma_f32_32x32x16_bf16 v[128:143], v[112:115], v[64:67], v[128:143]
  buffer_load_dwordx4 v[52:55], v2, s[20:23], s32 offen sc1
  ds_read_b64_tr_b16 v[120:121], v7 offset:10240
  ds_read_b64_tr_b16 v[122:123], v7 offset:11264
  v_mfma_f32_32x32x16_bf16 v[144:159], v[112:115], v[68:71], v[144:159]
  ds_read_b64_tr_b16 v[124:125], v8 offset:10240
  ds_read_b64_tr_b16 v[126:127], v8 offset:11264
  buffer_load_dwordx4 v5, s[24:27], s33 offen lds
  v_mfma_f32_32x32x16_bf16 v[160:175], v[112:115], v[72:75], v[160:175]
  v_mfma_f32_32x32x16_bf16 v[176:191], v[116:119], v[64:67], v[176:191]
  buffer_load_dwordx4 v[56:59], v3, s[20:23], s32 offen sc1
  v_mfma_f32_32x32x16_bf16 v[192:207], v[116:119], v[68:71], v[192:207]
  buffer_load_dwordx4 v6, s[24:27], s33 offen offset:1024 lds
  s_add_u32 s33, s33, 73728
  v_mfma_f32_32x32x16_bf16 v[208:223], v[116:119], v[72:75], v[208:223]
  buffer_load_dwordx4 v[60:63], v4, s[20:23], s32 offen sc1
  s_add_u32 s32, s32, 4096
  s_waitcnt vmcnt(25)
  s_waitcnt lgkmcnt(0)
  s_add_u32 m0, s34, 8192
  v_mfma_f32_32x32x16_bf16 v[128:143], v[120:123], v[76:79], v[128:143]
  buffer_load_dwordx4 v[64:67], v2, s[20:23], s32 offen sc1
  ds_read_b64_tr_b16 v[112:113], v7 offset:12288
  ds_read_b64_tr_b16 v[114:115], v7 offset:13312
  v_mfma_f32_32x32x16_bf16 v[144:159], v[120:123], v[80:83], v[144:159]
  ds_read_b64_tr_b16 v[116:117], v8 offset:12288
  ds_read_b64_tr_b16 v[118:119], v8 offset:13312
  buffer_load_dwordx4 v5, s[24:27], s33 offen lds
  v_mfma_f32_32x32x16_bf16 v[160:175], v[120:123], v[84:87], v[160:175]
  v_mfma_f32_32x32x16_bf16 v[176:191], v[124:127], v[76:79], v[176:191]
  buffer_load_dwordx4 v[68:71], v3, s[20:23], s32 offen sc1
  v_mfma_f32_32x32x16_bf16 v[192:207], v[124:127], v[80:83], v[192:207]
  buffer_load_dwordx4 v6, s[24:27], s33 offen offset:1024 lds
  s_add_u32 s33, s33, 73728
  v_mfma_f32_32x32x16_bf16 v[208:223], v[124:127], v[84:87], v[208:223]
  buffer_load_dwordx4 v[72:75], v4, s[20:23], s32 offen sc1
  s_add_u32 s32, s32, 4096
  s_waitcnt vmcnt(25)
  s_waitcnt lgkmcnt(0)
  s_add_u32 m0, s34, 10240
  v_mfma_f32_32x32x16_bf16 v[128:143], v[112:115], v[88:91], v[128:143]
  buffer_load_dwordx4 v[76:79], v2, s[20:23], s32 offen sc1
  ds_read_b64_tr_b16 v[120:121], v7 offset:14336
  ds_read_b64_tr_b16 v[122:123], v7 offset:15360
  v_mfma_f32_32x32x16_bf16 v[144:159], v[112:115], v[92:95], v[144:159]
  ds_read_b64_tr_b16 v[124:125], v8 offset:14336
  ds_read_b64_tr_b16 v[126:127], v8 offset:15360
  buffer_load_dwordx4 v5, s[24:27], s33 offen lds
  v_mfma_f32_32x32x16_bf16 v[160:175], v[112:115], v[96:99], v[160:175]
  v_mfma_f32_32x32x16_bf16 v[176:191], v[116:119], v[88:91], v[176:191]
  buffer_load_dwordx4 v[80:83], v3, s[20:23], s32 offen sc1
  v_mfma_f32_32x32x16_bf16 v[192:207], v[116:119], v[92:95], v[192:207]
  buffer_load_dwordx4 v6, s[24:27], s33 offen offset:1024 lds
  s_add_u32 s33, s33, 73728
  v_mfma_f32_32x32x16_bf16 v[208:223], v[116:119], v[96:99], v[208:223]
  buffer_load_dwordx4 v[84:87], v4, s[20:23], s32 offen sc1
  s_add_u32 s32, s32, 4096
  s_waitcnt vmcnt(25)
  s_waitcnt lgkmcnt(0)
  s_add_u32 m0, s34, 12288
  v_mfma_f32_32x32x16_bf16 v[128:143], v[120:123], v[100:103], v[128:143]
  buffer_load_dwordx4 v[88:91], v2, s[20:23], s32 offen sc1
  ds_read_b64_tr_b16 v[112:113], v7 offset:0
  ds_read_b64_tr_b16 v[114:115], v7 offset:1024
  v_mfma_f32_32x32x16_bf16 v[144:159], v[120:123], v[104:107], v[144:159]
  ds_read_b64_tr_b16 v[116:117], v8 offset:0
  ds_read_b64_tr_b16 v[118:119], v8 offset:1024
  buffer_load_dwordx4 v5, s[24:27], s33 offen lds
  v_mfma_f32_32x32x16_bf16 v[160:175], v[120:123], v[108:111], v[160:175]
  v_mfma_f32_32x32x16_bf16 v[176:191], v[124:127], v[100:103], v[176:191]
  buffer_load_dwordx4 v[92:95], v3, s[20:23], s32 offen sc1
  v_mfma_f32_32x32x16_bf16 v[192:207], v[124:127], v[104:107], v[192:207]
  buffer_load_dwordx4 v6, s[24:27], s33 offen offset:1024 lds
  s_add_u32 s33, s33, 73728
  v_mfma_f32_32x32x16_bf16 v[208:223], v[124:127], v[108:111], v[208:223]
  buffer_load_dwordx4 v[96:99], v4, s[20:23], s32 offen sc1
  s_add_u32 s32, s32, 4096
  s_add_u32 s35, s35, 1
  s_cmp_lt_u32 s35, 7
  s_cbranch_scc1 OP_LOOP
  s_waitcnt vmcnt(25)
  s_waitcnt lgkmcnt(0)
  s_add_u32 m0, s34, 14336
  v_mfma_f32_32x32x16_bf16 v[128:143], v[112:115], v[16:19], v[128:143]
  buffer_load_dwordx4 v[100:103], v2, s[20:23], s32 offen sc1
  ds_read_b64_tr_b16 v[120:121], v7 offset:2048
  ds_read_b64_tr_b16 v[122:123], v7 offset:3072
  v_mfma_f32_32x32x16_bf16 v[144:159], v[112:115], v[20:23], v[144:159]
  ds_read_b64_tr_b16 v[124:125], v8 offset:2048
  ds_read_b64_tr_b16 v[126:127], v8 offset:3072
  buffer_load_dwordx4 v5, s[24:27], s33 offen lds
  v_mfma_f32_32x32x16_bf16 v[160:175], v[112:115], v[24:27], v[160:175]
  v_mfma_f32_32x32x16_bf16 v[176:191], v[116:119], v[16:19], v[176:191]
  buffer_load_dwordx4 v[104:107], v3, s[20:23], s32 offen sc1
  v_mfma_f32_32x32x16_bf16 v[192:207], v[116:119], v[20:23], v[192:207]
  buffer_load_dwordx4 v6, s[24:27], s33 offen offset:1024 lds
  s_add_u32 s33, s33, 73728
  v_mfma_f32_32x32x16_bf16 v[208:223], v[116:119], v[24:27], v[208:223]
  buffer_load_dwordx4 v[108:111], v4, s[20:23], s32 offen sc1
  s_add_u32 s32, s32, 4096
  s_waitcnt vmcnt(25)
  s_waitcnt lgkmcnt(0)
  v_mfma_f32_32x32x16_bf16 v[128:143], v[120:123], v[28:31], v[128:143]
  ds_read_b64_tr_b16 v[112:113], v7 offset:4096
  ds_read_b64_tr_b16 v[114:115], v7 offset:5120
  v_mfma_f32_32x32x16_bf16 v[144:159], v[120:123], v[32:35], v[144:159]
  ds_read_b64_tr_b16 v[116:117], v8 offset:4096
  ds_read_b64_tr_b16 v[118:119], v8 offset:5120
  v_mfma_f32_32x32x16_bf16 v[160:175], v[120:123], v[36:39], v[160:175]
  v_mfma_f32_32x32x16_bf16 v[176:191], v[124:127], v[28:31], v[176:191]
  v_mfma_f32_32x32x16_bf16 v[192:207], v[124:127], v[32:35], v[192:207]
  v_mfma_f32_32x32x16_bf16 v[208:223], v[124:127], v[36:39], v[208:223]
  s_waitcnt vmcnt(20)
  s_waitcnt lgkmcnt(0)
  v_mfma_f32_32x32x16_bf16 v[128:143], v[112:115], v[40:43], v[128:143]
  ds_read_b64_tr_b16 v[120:121], v7 offset:6144
  ds_read_b64_tr_b16 v[122:123], v7 offset:7168
  v_mfma_f32_32x32x16_bf16 v[144:159], v[112:115], v[44:47], v[144:159]
  ds_read_b64_tr_b16 v[124:125], v8 offset:6144
  ds_read_b64_tr_b16 v[126:127], v8 offset:7168
  v_mfma_f32_32x32x16_bf16 v[160:175], v[112:115], v[48:51], v[160:175]
  v_mfma_f32_32x32x16_bf16 v[176:191], v[116:119], v[40:43], v[176:191]
  v_mfma_f32_32x32x16_bf16 v[192:207], v[116:119], v[44:47], v[192:207]
  v_mfma_f32_32x32x16_bf16 v[208:223], v[116:119], v[48:51], v[208:223]
  s_waitcnt vmcnt(15)
  s_waitcnt lgkmcnt(0)
  v_mfma_f32_32x32x16_bf16 v[128:143], v[120:123], v[52:55], v[128:143]
  ds_read_b64_tr_b16 v[112:113], v7 offset:8192
  ds_read_b64_tr_b16 v[114:115], v7 offset:9216
  v_mfma_f32_32x32x16_bf16 v[144:159], v[120:123], v[56:59], v[144:159]
  ds_read_b64_tr_b16 v[116:117], v8 offset:8192
  ds_read_b64_tr_b16 v[118:119], v8 offset:9216
  v_mfma_f32_32x32x16_bf16 v[160:175], v[120:123], v[60:63], v[160:175]
  v_mfma_f32_32x32x16_bf16 v[176:191], v[124:127], v[52:55], v[176:191]
  v_mfma_f32_32x32x16_bf16 v[192:207], v[124:127], v[56:59], v[192:207]
  v_mfma_f32_32x32x16_bf16 v[208:223], v[124:127], v[60:63], v[208:223]
  s_waitcnt vmcnt(10)
  s_waitcnt lgkmcnt(0)
  v_mfma_f32_32x32x16_bf16 v[128:143], v[112:115], v[64:67], v[128:143]
  ds_read_b64_tr_b16 v[120:121], v7 offset:10240
  ds_read_b64_tr_b16 v[122:123], v7 offset:11264
  v_mfma_f32_32x32x16_bf16 v[144:159], v[112:115], v[68:71], v[144:159]
  ds_read_b64_tr_b16 v[124:125], v8 offset:10240
  ds_read_b64_tr_b16 v[126:127], v8 offset:11264
  v_mfma_f32_32x32x16_bf16 v[160:175], v[112:115], v[72:75], v[160:175]
  v_mfma_f32_32x32x16_bf16 v[176:191], v[116:119], v[64:67], v[176:191]
  v_mfma_f32_32x32x16_bf16 v[192:207], v[116:119], v[68:71], v[192:207]
  v_mfma_f32_32x32x16_bf16 v[208:223], v[116:119], v[72:75], v[208:223]
  s_waitcnt vmcnt(5)
  s_waitcnt lgkmcnt(0)
  v_mfma_f32_32x32x16_bf16 v[128:143], v[120:123], v[76:79], v[128:143]
  ds_read_b64_tr_b16 v[112:113], v7 offset:12288
  ds_read_b64_tr_b16 v[114:115], v7 offset:13312
  v_mfma_f32_32x32x16_bf16 v[144:159], v[120:123], v[80:83], v[144:159]
  ds_read_b64_tr_b16 v[116:117], v8 offset:12288
  ds_read_b64_tr_b16 v[118:119], v8 offset:13312
  v_mfma_f32_32x32x16_bf16 v[160:175], v[120:123], v[84:87], v[160:175]
  v_mfma_f32_32x32x16_bf16 v[176:191], v[124:127], v[76:79], v[176:191]
  v_mfma_f32_32x32x16_bf16 v[192:207], v[124:127], v[80:83], v[192:207]
  v_mfma_f32_32x32x16_bf16 v[208:223], v[124:127], v[84:87], v[208:223]
  s_waitcnt vmcnt(0)
  s_waitcnt lgkmcnt(0)
  v_mfma_f32_32x32x16_bf16 v[128:143], v[112:115], v[88:91], v[128:143]
  ds_read_b64_tr_b16 v[120:121], v7 offset:14336
  ds_read_b64_tr_b16 v[122:123], v7 offset:15360
  v_mfma_f32_32x32x16_bf16 v[144:159], v[112:115], v[92:95], v[144:159]
  ds_read_b64_tr_b16 v[124:125], v8 offset:14336
  ds_read_b64_tr_b16 v[126:127], v8 offset:15360
  v_mfma_f32_32x32x16_bf16 v[160:175], v[112:115], v[96:99], v[160:175]
  v_mfma_f32_32x32x16_bf16 v[176:191], v[116:119], v[88:91], v[176:191]
  v_mfma_f32_32x32x16_bf16 v[192:207], v[116:119], v[92:95], v[192:207]
  v_mfma_f32_32x32x16_bf16 v[208:223], v[116:119], v[96:99], v[208:223]
  s_waitcnt lgkmcnt(0)
  v_mfma_f32_32x32x16_bf16 v[128:143], v[120:123], v[100:103], v[128:143]
  v_mfma_f32_32x32x16_bf16 v[144:159], v[120:123], v[104:107], v[144:159]
  v_mfma_f32_32x32x16_bf16 v[160:175], v[120:123], v[108:111], v[160:175]
  v_mfma_f32_32x32x16_bf16 v[176:191], v[124:127], v[100:103], v[176:191]
  v_mfma_f32_32x32x16_bf16 v[192:207], v[124:127], v[104:107], v[192:207]
  v_mfma_f32_32x32x16_bf16 v[208:223], v[124:127], v[108:111], v[208:223]
  s_mov_b32 s14, 2654208
  s_mov_b32 s15, 0x20000
  s_nop 15
  s_nop 7
  s_waitcnt lgkmcnt(0)
  s_barrier
  v_lshlrev_b32 v2, 4, v0
  s_mul_i32 s40, s3, 24576
  v_add_u32 v3, s40, v2
  ds_write_b128 v3, v[128:131] offset:0
  ds_write_b128 v3, v[132:135] offset:1024
  ds_write_b128 v3, v[136:139] offset:2048
  ds_write_b128 v3, v[140:143] offset:3072
  ds_write_b128 v3, v[144:147] offset:4096
  ds_write_b128 v3, v[148:151] offset:5120
  ds_write_b128 v3, v[152:155] offset:6144
  ds_write_b128 v3, v[156:159] offset:7168
  ds_write_b128 v3, v[160:163] offset:8192
  ds_write_b128 v3, v[164:167] offset:9216
  ds_write_b128 v3, v[168:171] offset:10240
  ds_write_b128 v3, v[172:175] offset:11264
  ds_write_b128 v3, v[176:179] offset:12288
  ds_write_b128 v3, v[180:183] offset:13312
  ds_write_b128 v3, v[184:187] offset:14336
  ds_write_b128 v3, v[188:191] offset:15360
  ds_write_b128 v3, v[192:195] offset:16384
  ds_write_b128 v3, v[196:199] offset:17408
  ds_write_b128 v3, v[200:203] offset:18432
  ds_write_b128 v3, v[204:207] offset:19456
  ds_write_b128 v3, v[208:211] offset:20480
  ds_write_b128 v3, v[212:215] offset:21504
  ds_write_b128 v3, v[216:219] offset:22528
  ds_write_b128 v3, v[220:223] offset:23552
  s_mul_i32 s45, s55, 96
  v_and_b32 v5, 31, v0
  v_add_u32 v5, s45, v5
  v_mul_u32_u24 v5, 1152, v5
  v_lshrrev_b32 v6, 5, v0
  v_lshl_add_u32 v5, v6, 3, v5
  s_lshl_b32 s46, s61, 7
  s_lshl_b32 s47, s3, 4
  s_add_u32 s46, s46, s47
  v_add_u32 v5, s46, v5
  v_add_u32 v6, 36864, v5
  v_add_u32 v7, 73728, v5
  s_lshl_b32 s40, s3, 10
  v_add_u32 v3, s40, v2
  v_add_u32 v4, 49152, v3
  s_waitcnt lgkmcnt(0)
  s_barrier
  ds_read_b128 v[16:19], v3 offset:0
  ds_read_b128 v[20:23], v3 offset:24576
  ds_read_b128 v[24:27], v4 offset:0
  ds_read_b128 v[28:31], v4 offset:24576
  ds_read_b128 v[32:35], v3 offset:4096
  ds_read_b128 v[36:39], v3 offset:28672
  ds_read_b128 v[40:43], v4 offset:4096
  ds_read_b128 v[44:47], v4 offset:28672
  ds_read_b128 v[48:51], v3 offset:8192
  ds_read_b128 v[52:55], v3 offset:32768
  ds_read_b128 v[56:59], v4 offset:8192
  ds_read_b128 v[60:63], v4 offset:32768
  ds_read_b128 v[64:67], v3 offset:12288
  ds_read_b128 v[68:71], v3 offset:36864
  ds_read_b128 v[72:75], v4 offset:12288
  ds_read_b128 v[76:79], v4 offset:36864
  ds_read_b128 v[80:83], v3 offset:16384
  ds_read_b128 v[84:87], v3 offset:40960
  ds_read_b128 v[88:91], v4 offset:16384
  ds_read_b128 v[92:95], v4 offset:40960
  ds_read_b128 v[96:99], v3 offset:20480
  ds_read_b128 v[100:103], v3 offset:45056
  ds_read_b128 v[104:107], v4 offset:20480
  ds_read_b128 v[108:111], v4 offset:45056
  v_and_b32 v8, 31, v0
  v_lshrrev_b32 v9, 5, v0
  v_and_b32 v10, 7, v0
  v_xor_b32 v10, s3, v10
  v_lshlrev_b32 v11, 7, v8
  v_lshl_add_u32 v11, v10, 4, v11
  v_lshl_add_u32 v11, v9, 3, v11
  v_add_u32 v11, 98304, v11
  v_xor_b32 v12, 64, v11
  s_waitcnt lgkmcnt(15)
  v_add_f32 v16, v16, v20
  v_add_f32 v24, v24, v28
  v_add_f32 v16, v16, v24
  v_add_f32 v17, v17, v21
  v_add_f32 v25, v25, v29
  v_add_f32 v17, v17, v25
  v_add_f32 v18, v18, v22
  v_add_f32 v26, v26, v30
  v_add_f32 v18, v18, v26
  v_add_f32 v19, v19, v23
  v_add_f32 v27, v27, v31
  v_add_f32 v19, v19, v27
  v_cvt_pk_bf16_f32 v20, v16, v17
  v_cvt_pk_bf16_f32 v21, v18, v19
  ds_write_b64 v11, v[20:21] offset:0
  s_waitcnt lgkmcnt(15)
  v_add_f32 v32, v32, v36
  v_add_f32 v40, v40, v44
  v_add_f32 v32, v32, v40
  v_add_f32 v33, v33, v37
  v_add_f32 v41, v41, v45
  v_add_f32 v33, v33, v41
  v_add_f32 v34, v34, v38
  v_add_f32 v42, v42, v46
  v_add_f32 v34, v34, v42
  v_add_f32 v35, v35, v39
  v_add_f32 v43, v43, v47
  v_add_f32 v35, v35, v43
  v_cvt_pk_bf16_f32 v36, v32, v33
  v_cvt_pk_bf16_f32 v37, v34, v35
  ds_write_b64 v11, v[36:37] offset:4096
  s_waitcnt lgkmcnt(14)
  v_add_f32 v48, v48, v52
  v_add_f32 v56, v56, v60
  v_add_f32 v48, v48, v56
  v_add_f32 v49, v49, v53
  v_add_f32 v57, v57, v61
  v_add_f32 v49, v49, v57
  v_add_f32 v50, v50, v54
  v_add_f32 v58, v58, v62
  v_add_f32 v50, v50, v58
  v_add_f32 v51, v51, v55
  v_add_f32 v59, v59, v63
  v_add_f32 v51, v51, v59
  v_cvt_pk_bf16_f32 v52, v48, v49
  v_cvt_pk_bf16_f32 v53, v50, v51
  ds_write_b64 v11, v[52:53] offset:8192
  s_waitcnt lgkmcnt(11)
  v_add_f32 v64, v64, v68
  v_add_f32 v72, v72, v76
  v_add_f32 v64, v64, v72
  v_add_f32 v65, v65, v69
  v_add_f32 v73, v73, v77
  v_add_f32 v65, v65, v73
  v_add_f32 v66, v66, v70
  v_add_f32 v74, v74, v78
  v_add_f32 v66, v66, v74
  v_add_f32 v67, v67, v71
  v_add_f32 v75, v75, v79
  v_add_f32 v67, v67, v75
  v_cvt_pk_bf16_f32 v68, v64, v65
  v_cvt_pk_bf16_f32 v69, v66, v67
  ds_write_b64 v12, v[68:69] offset:0
  s_waitcnt lgkmcnt(8)
  v_add_f32 v80, v80, v84
  v_add_f32 v88, v88, v92
  v_add_f32 v80, v80, v88
  v_add_f32 v81, v81, v85
  v_add_f32 v89, v89, v93
  v_add_f32 v81, v81, v89
  v_add_f32 v82, v82, v86
  v_add_f32 v90, v90, v94
  v_add_f32 v82, v82, v90
  v_add_f32 v83, v83, v87
  v_add_f32 v91, v91, v95
  v_add_f32 v83, v83, v91
  v_cvt_pk_bf16_f32 v84, v80, v81
  v_cvt_pk_bf16_f32 v85, v82, v83
  ds_write_b64 v12, v[84:85] offset:4096
  s_waitcnt lgkmcnt(5)
  v_add_f32 v96, v96, v100
  v_add_f32 v104, v104, v108
  v_add_f32 v96, v96, v104
  v_add_f32 v97, v97, v101
  v_add_f32 v105, v105, v109
  v_add_f32 v97, v97, v105
  v_add_f32 v98, v98, v102
  v_add_f32 v106, v106, v110
  v_add_f32 v98, v98, v106
  v_add_f32 v99, v99, v103
  v_add_f32 v107, v107, v111
  v_add_f32 v99, v99, v107
  v_cvt_pk_bf16_f32 v100, v96, v97
  v_cvt_pk_bf16_f32 v101, v98, v99
  ds_write_b64 v12, v[100:101] offset:8192
  s_mul_i32 s40, s3, 24
  v_lshrrev_b32 v8, 3, v0
  v_add_u32 v8, s40, v8
  v_and_b32 v9, 7, v0
  v_lshlrev_b32 v10, 7, v8
  v_lshl_add_u32 v10, v9, 4, v10
  v_add_u32 v10, 98304, v10
  v_and_b32 v13, 7, v8
  v_xor_b32 v13, v13, v9
  s_mul_i32 s45, s55, 96
  v_add_u32 v8, s45, v8
  v_mul_u32_u24 v8, 1152, v8
  v_lshl_add_u32 v8, v13, 4, v8
  s_lshl_b32 s46, s61, 7
  s_waitcnt lgkmcnt(0)
  s_barrier
  ds_read_b128 v[16:19], v10
  ds_read_b128 v[20:23], v10 offset:1024
  ds_read_b128 v[24:27], v10 offset:2048
  v_add_u32 v9, 9216, v8
  v_add_u32 v13, 18432, v8
  s_waitcnt lgkmcnt(2)
  buffer_store_dwordx4 v[16:19], v8, s[12:15], s46 offen
  s_waitcnt lgkmcnt(1)
  buffer_store_dwordx4 v[20:23], v9, s[12:15], s46 offen
  s_waitcnt lgkmcnt(0)
  buffer_store_dwordx4 v[24:27], v13, s[12:15], s46 offen
  s_branch K1_END
K1_NOTILE:
  s_waitcnt vmcnt(0)
  s_barrier
  s_cmp_eq_u32 s3, 0
  s_cbranch_scc0 K1_SIGd
  s_lshl_b32 s40, s28, 4
  s_add_u32 s40, s40, s29
  s_lshl_b32 s40, s40, 7
  s_add_u32 s40, s40, 19955712
  v_mov_b32 v242, s40
  v_mov_b32 v243, s97
  s_mov_b64 exec, 1
  global_store_dword v242, v243, s[20:21] sc1
  s_mov_b64 exec, -1
K1_SIGd:
  s_branch K1_END
K1_FIN3:
  s_and_b32 s40, s2, 7
  s_lshr_b32 s41, s2, 3
  s_lshr_b32 s42, s41, 3
  s_lshl_b32 s42, s42, 2
  s_and_b32 s43, s41, 3
  s_add_u32 s42, s42, s43
  s_bitcmp1_b32 s41, 2
  s_cselect_b32 s43, 16, 0
  s_add_u32 s41, s42, s43
  s_mul_i32 s42, s41, 57
  s_lshr_b32 s42, s42, 9
  s_mul_i32 s43, s42, 9
  s_sub_u32 s61, s41, s43
  s_mul_i32 s44, s40, 3
  s_add_u32 s55, s44, s42
  s_mul_i32 s46, s55, 96
  s_add_u32 s47, s46, 95
  s_mul_i32 s46, s46, 29128
  s_lshr_b32 s46, s46, 22
  s_mul_i32 s47, s47, 29128
  s_lshr_b32 s47, s47, 22
  s_min_u32 s46, s46, 15
  s_min_u32 s47, s47, 15
  s_lshl_b32 s62, s46, 11
  s_lshl_b32 s67, s47, 11
  s_cmp_eq_u32 s3, 0
  s_cbranch_scc0 OP_PFc
  s_mov_b64 exec, 0xffffffff
  v_and_b32 v241, 15, v0
  v_lshlrev_b32 v241, 7, v241
  v_mov_b32 v240, s62
  v_mov_b32 v242, s67
  v_cmp_gt_u32 vcc, 16, v0
  s_nop 1
  v_cndmask_b32 v240, v242, v240, vcc
  v_add_u32 v240, v240, v241
  v_add_u32 v240, 19922944, v240
  global_load_dword v241, v240, s[20:21] sc1
  s_mov_b64 exec, -1
OP_PFc:
  s_cmp_eq_u32 s3, 0
  s_cbranch_scc0 OP_OK2
  s_waitcnt vmcnt(0)
OP_CHK2:
  s_mov_b64 exec, 0xffffffff
  v_cmp_ne_u32 vcc, s97, v241
  s_mov_b64 exec, -1
  s_nop 3
  s_cmp_eq_u32 vcc_lo, 0
  s_cbranch_scc1 OP_OK2
  s_sleep 8
  s_mov_b64 exec, 0xffffffff
  v_and_b32 v241, 15, v0
  v_lshlrev_b32 v241, 7, v241
  v_mov_b32 v240, s62
  v_mov_b32 v242, s67
  v_cmp_gt_u32 vcc, 16, v0
  s_nop 1
  v_cndmask_b32 v240, v242, v240, vcc
  v_add_u32 v240, v240, v241
  v_add_u32 v240, 19922944, v240
  global_load_dword v241, v240, s[20:21] sc1
  s_mov_b64 exec, -1
  s_waitcnt vmcnt(0)
  s_branch OP_CHK2
OP_OK2:
  s_barrier
  s_branch K1_FIN2
K1_SLOW_NEXT:
  s_waitcnt vmcnt(0) lgkmcnt(0)
  s_barrier
  s_bitcmp1_b32 s95, 2
  s_cbranch_scc0 K1_SLOW_PICK
  s_cmp_eq_u32 s30, 0
  s_cbranch_scc0 K1_SLOW_PICK
  s_cmp_eq_u32 s3, 0
  s_cbranch_scc0 K1_SIGc
  s_lshl_b32 s40, s28, 4
  s_add_u32 s40, s40, s29
  s_lshl_b32 s40, s40, 7
  s_add_u32 s40, s40, 19922944
  v_mov_b32 v242, s40
  v_mov_b32 v243, s97
  s_mov_b64 exec, 1
  global_store_dword v242, v243, s[20:21] sc1
  s_mov_b64 exec, -1
K1_SIGc:
K1_SLOW_PICK:
  s_bitcmp1_b32 s95, 0
  s_cbranch_scc0 K1_SLOW_P1
  s_mov_b32 s30, 0
  s_and_b32 s95, s95, 6
  s_branch K1_SLOW_RUN
K1_SLOW_P1:
  s_bitcmp1_b32 s95, 1
  s_cbranch_scc0 K1_FIN3
  s_mov_b32 s30, 1
  s_and_b32 s95, s95, 5
K1_SLOW_RUN:
  s_or_b32 s95, s95, 4
  s_lshl_b32 s40, s30, 4
  s_add_u32 s31, s29, s40
  s_lshl_b32 s37, s31, 17
  s_add_u32 s37, s37, s38
  s_mov_b32 s67, 0
  s_mov_b32 s62, 150528
  s_lshl_b32 s33, s31, 8
  s_add_u32 s63, s33, 31744
  s_mov_b32 s32, 0
  s_mov_b32 s58, 17408
  s_mov_b32 s59, 34816
  s_add_u32 m0, s56, 107520
  s_nop 0
  buffer_load_dwordx4 v31, s[8:11], s33 offen lds
  buffer_load_dwordx4 v31, s[8:11], s63 offen offset:1024 lds
  s_add_u32 m0, s57, 98304
  s_add_u32 s33, s33, 262144
  s_add_u32 s63, s63, 262144
  buffer_load_dwordx4 v30, s[4:7], s32 offen offset:0 lds
  s_add_u32 s32, s32, 64
  buffer_load_dwordx4 v30, s[4:7], s58 offen offset:1024 lds
  s_add_u32 s58, s58, 64
  s_mov_b64 exec, 0xffff
  buffer_load_dwordx4 v30, s[4:7], s59 offen offset:2048 lds
  s_mov_b64 exec, -1
  s_add_u32 s59, s59, 64
  s_add_u32 m0, s56, 124928
  s_nop 0
  buffer_load_dwordx4 v31, s[8:11], s33 offen lds
  buffer_load_dwordx4 v31, s[8:11], s63 offen offset:1024 lds
  s_add_u32 m0, s57, 115712
  s_add_u32 s33, s33, 262144
  s_add_u32 s63, s63, 262144
  buffer_load_dwordx4 v30, s[4:7], s32 offen offset:0 lds
  s_add_u32 s32, s32, 64
  buffer_load_dwordx4 v30, s[4:7], s58 offen offset:1024 lds
  s_add_u32 s58, s58, 64
  s_mov_b64 exec, 0xffff
  buffer_load_dwordx4 v30, s[4:7], s59 offen offset:2048 lds
  s_mov_b64 exec, -1
  s_add_u32 s59, s59, 64
  s_add_u32 m0, s56, 142336
  s_nop 0
  buffer_load_dwordx4 v31, s[8:11], s33 offen lds
  buffer_load_dwordx4 v31, s[8:11], s63 offen offset:1024 lds
  s_add_u32 m0, s57, 133120
  s_add_u32 s33, s33, 262144
  s_add_u32 s63, s63, 262144
  buffer_load_dwordx4 v30, s[4:7], s32 offen offset:0 lds
  s_add_u32 s32, s32, 64
  buffer_load_dwordx4 v30, s[4:7], s58 offen offset:1024 lds
  s_add_u32 s58, s58, 64
  s_mov_b64 exec, 0xffff
  buffer_load_dwordx4 v30, s[4:7], s59 offen offset:2048 lds
  s_mov_b64 exec, -1
  s_add_u32 s59, s59, 64
  s_branch K1_Q
K1_SLOW_ATT:
  s_waitcnt vmcnt(0) lgkmcnt(0)
  s_barrier
  v_and_b32 v1, 15, v0
  v_lshrrev_b32 v2, 4, v0
  v_lshlrev_b32 v8, 8, v1
  v_xor_b32 v9, v2, v1
  v_lshl_add_u32 v8, v9, 4, v8
  v_add_u32 v8, s62, v8
  v_xor_b32 v9, 0, v8
  ds_read_b128 a[64:67], v9
  v_xor_b32 v9, 64, v8
  ds_read_b128 a[68:71], v9
  v_xor_b32 v9, 128, v8
  ds_read_b128 a[72:75], v9
  v_xor_b32 v9, 192, v8
  ds_read_b128 a[76:79], v9
  v_mfma_f32_32x32x16_bf16 v[128:143], v[76:79], v[76:79], 0
  v_mfma_f32_32x32x16_bf16 v[144:159], v[76:79], v[76:79], 0
  v_mfma_f32_32x32x16_bf16 v[160:175], v[76:79], v[76:79], 0
  v_mfma_f32_32x32x16_bf16 v[176:191], v[76:79], v[76:79], 0
  v_mfma_f32_16x16x32_bf16 a[176:179], v[76:79], v[76:79], 0
  v_mfma_f32_16x16x32_bf16 a[180:183], v[76:79], v[76:79], 0
  v_mfma_f32_16x16x32_bf16 a[184:187], v[76:79], v[76:79], 0
  v_mfma_f32_16x16x32_bf16 a[188:191], v[76:79], v[76:79], 0
  v_mfma_f32_16x16x32_bf16 a[192:195], v[76:79], v[76:79], 0
  v_mfma_f32_16x16x32_bf16 a[196:199], v[76:79], v[76:79], 0
  v_mfma_f32_16x16x32_bf16 a[200:203], v[76:79], v[76:79], 0
  v_mfma_f32_16x16x32_bf16 a[204:207], v[76:79], v[76:79], 0
  v_mov_b32 v64, 0
  v_mov_b32 v66, 0
  v_mov_b32 v20, 0xff800000
  v_mov_b32 v21, 0xff800000
  s_mov_b32 s34, 0
  s_mov_b32 s50, s37
K1_SLOW_L1:
  s_add_u32 m0, s38, 0
  s_nop 0
  buffer_load_dwordx4 v34, s[12:15], s50 offen offset:0 lds
  buffer_load_dwordx4 v35, s[12:15], s50 offen offset:1024 lds
  buffer_load_dwordx4 v36, s[12:15], s50 offen offset:2048 lds
  buffer_load_dwordx4 v37, s[12:15], s50 offen offset:3072 lds
  s_waitcnt vmcnt(0) lgkmcnt(0)
  s_barrier
  ds_read_b128 a[80:83], v40 offset:0
  ds_read_b128 a[84:87], v41 offset:0
  ds_read_b128 a[88:91], v42 offset:0
  ds_read_b128 a[92:95], v43 offset:0
  ds_read_b128 a[96:99], v44 offset:0
  ds_read_b128 a[100:103], v45 offset:0
  ds_read_b128 a[104:107], v46 offset:0
  ds_read_b128 a[108:111], v47 offset:0
  s_waitcnt lgkmcnt(0)
  v_mfma_f32_32x32x16_bf16 v[96:111], a[80:83], v[192:195], 0
  v_mfma_f32_32x32x16_bf16 v[96:111], a[84:87], v[196:199], v[96:111]
  v_mfma_f32_32x32x16_bf16 v[96:111], a[88:91], v[200:203], v[96:111]
  v_mfma_f32_32x32x16_bf16 v[96:111], a[92:95], v[204:207], v[96:111]
  v_mfma_f32_32x32x16_bf16 v[96:111], a[96:99], v[208:211], v[96:111]
  v_mfma_f32_32x32x16_bf16 v[96:111], a[100:103], v[212:215], v[96:111]
  v_mfma_f32_32x32x16_bf16 v[96:111], a[104:107], v[216:219], v[96:111]
  v_mfma_f32_32x32x16_bf16 v[96:111], a[108:111], v[220:223], v[96:111]
  s_nop 15
  s_nop 7
  v_max_f32 v20, v20, v96
  v_max_f32 v20, v20, v97
  v_max_f32 v20, v20, v98
  v_max_f32 v20, v20, v99
  v_max_f32 v20, v20, v100
  v_max_f32 v20, v20, v101
  v_max_f32 v20, v20, v102
  v_max_f32 v20, v20, v103
  v_max_f32 v20, v20, v104
  v_max_f32 v20, v20, v105
  v_max_f32 v20, v20, v106
  v_max_f32 v20, v20, v107
  v_max_f32 v20, v20, v108
  v_max_f32 v20, v20, v109
  v_max_f32 v20, v20, v110
  v_max_f32 v20, v20, v111
  ds_read_b128 a[80:83], v40 offset:8192
  ds_read_b128 a[84:87], v41 offset:8192
  ds_read_b128 a[88:91], v42 offset:8192
  ds_read_b128 a[92:95], v43 offset:8192
  ds_read_b128 a[96:99], v44 offset:8192
  ds_read_b128 a[100:103], v45 offset:8192
  ds_read_b128 a[104:107], v46 offset:8192
  ds_read_b128 a[108:111], v47 offset:8192
  s_waitcnt lgkmcnt(0)
  v_mfma_f32_32x32x16_bf16 v[96:111], a[80:83], v[192:195], 0
  v_mfma_f32_32x32x16_bf16 v[96:111], a[84:87], v[196:199], v[96:111]
  v_mfma_f32_32x32x16_bf16 v[96:111], a[88:91], v[200:203], v[96:111]
  v_mfma_f32_32x32x16_bf16 v[96:111], a[92:95], v[204:207], v[96:111]
  v_mfma_f32_32x32x16_bf16 v[96:111], a[96:99], v[208:211], v[96:111]
  v_mfma_f32_32x32x16_bf16 v[96:111], a[100:103], v[212:215], v[96:111]
  v_mfma_f32_32x32x16_bf16 v[96:111], a[104:107], v[216:219], v[96:111]
  v_mfma_f32_32x32x16_bf16 v[96:111], a[108:111], v[220:223], v[96:111]
  s_nop 15
  s_nop 7
  v_max_f32 v20, v20, v96
  v_max_f32 v20, v20, v97
  v_max_f32 v20, v20, v98
  v_max_f32 v20, v20, v99
  v_max_f32 v20, v20, v100
  v_max_f32 v20, v20, v101
  v_max_f32 v20, v20, v102
  v_max_f32 v20, v20, v103
  v_max_f32 v20, v20, v104
  v_max_f32 v20, v20, v105
  v_max_f32 v20, v20, v106
  v_max_f32 v20, v20, v107
  v_max_f32 v20, v20, v108
  v_max_f32 v20, v20, v109
  v_max_f32 v20, v20, v110
  v_max_f32 v20, v20, v111
  ds_read_b128 a[112:115], v52 offset:0
  ds_read_b128 a[116:119], v53 offset:0
  ds_read_b128 a[120:123], v54 offset:0
  ds_read_b128 a[124:127], v55 offset:0
  s_waitcnt lgkmcnt(0)
  v_mfma_f32_16x16x32_bf16 v[72:75], a[112:115], a[64:67], 0
  v_mfma_f32_16x16x32_bf16 v[72:75], a[116:119], a[68:71], v[72:75]
  v_mfma_f32_16x16x32_bf16 v[72:75], a[120:123], a[72:75], v[72:75]
  v_mfma_f32_16x16x32_bf16 v[72:75], a[124:127], a[76:79], v[72:75]
  s_nop 15
  v_max_f32 v21, v21, v72
  v_max_f32 v21, v21, v73
  v_max_f32 v21, v21, v74
  v_max_f32 v21, v21, v75
  s_barrier
  s_add_u32 s50, s50, 16384
  s_add_u32 s34, s34, 1
  s_cmp_lt_u32 s34, 8
  s_cbranch_scc1 K1_SLOW_L1
  v_mov_b32 v1, v20
  v_mov_b32 v2, v21
  s_nop 1
  v_permlane32_swap_b32 v20, v1
  v_permlane16_swap_b32 v21, v2
  s_nop 1
  v_max_f32 v20, v20, v1
  v_max_f32 v21, v21, v2
  v_mov_b32 v2, v21
  s_nop 1
  v_permlane32_swap_b32 v21, v2
  s_nop 1
  v_max_f32 v21, v21, v2
  v_lshlrev_b32 v5, 2, v0
  s_lshl_b32 s42, s3, 8
  v_add_u32 v6, s42, v5
  v_add_u32 v6, 148480, v6
  v_add_u32 v5, 148480, v5
  ds_write_b32 v6, v21
  s_waitcnt lgkmcnt(0)
  s_barrier
  ds_read_b32 v12, v5
  ds_read_b32 v13, v5 offset:256
  ds_read_b32 v14, v5 offset:512
  ds_read_b32 v15, v5 offset:768
  s_waitcnt lgkmcnt(0)
  v_max_f32 v12, v12, v13
  v_max_f32 v14, v14, v15
  v_max_f32 v21, v12, v14
  s_barrier
  s_mov_b32 s34, 0
  s_mov_b32 s50, s37
K1_SLOW_L2:
  s_add_u32 m0, s38, 0
  s_nop 0
  buffer_load_dwordx4 v34, s[12:15], s50 offen offset:0 lds
  buffer_load_dwordx4 v35, s[12:15], s50 offen offset:1024 lds
  buffer_load_dwordx4 v36, s[12:15], s50 offen offset:2048 lds
  buffer_load_dwordx4 v37, s[12:15], s50 offen offset:3072 lds
  s_add_u32 m0, s38, 49152
  s_nop 0
  buffer_load_dwordx4 v38, s[16:19], s50 offen offset:0 lds
  buffer_load_dwordx4 v39, s[16:19], s50 offen offset:1024 lds
  buffer_load_dwordx4 v38, s[16:19], s50 offen offset:2048 lds
  buffer_load_dwordx4 v39, s[16:19], s50 offen offset:3072 lds
  s_waitcnt vmcnt(0) lgkmcnt(0)
  s_barrier
  ds_read_b128 a[80:83], v40 offset:0
  ds_read_b128 a[84:87], v41 offset:0
  ds_read_b128 a[88:91], v42 offset:0
  ds_read_b128 a[92:95], v43 offset:0
  ds_read_b128 a[96:99], v44 offset:0
  ds_read_b128 a[100:103], v45 offset:0
  ds_read_b128 a[104:107], v46 offset:0
  ds_read_b128 a[108:111], v47 offset:0
  s_waitcnt lgkmcnt(0)
  v_mfma_f32_32x32x16_bf16 v[96:111], a[80:83], v[192:195], 0
  v_mfma_f32_32x32x16_bf16 v[96:111], a[84:87], v[196:199], v[96:111]
  v_mfma_f32_32x32x16_bf16 v[96:111], a[88:91], v[200:203], v[96:111]
  v_mfma_f32_32x32x16_bf16 v[96:111], a[92:95], v[204:207], v[96:111]
  v_mfma_f32_32x32x16_bf16 v[96:111], a[96:99], v[208:211], v[96:111]
  v_mfma_f32_32x32x16_bf16 v[96:111], a[100:103], v[212:215], v[96:111]
  v_mfma_f32_32x32x16_bf16 v[96:111], a[104:107], v[216:219], v[96:111]
  v_mfma_f32_32x32x16_bf16 v[96:111], a[108:111], v[220:223], v[96:111]
  s_nop 15
  s_nop 7
  v_sub_f32 v96, v96, v20
  v_sub_f32 v97, v97, v20
  v_sub_f32 v98, v98, v20
  v_sub_f32 v99, v99, v20
  v_sub_f32 v100, v100, v20
  v_sub_f32 v101, v101, v20
  v_sub_f32 v102, v102, v20
  v_sub_f32 v103, v103, v20
  v_sub_f32 v104, v104, v20
  v_sub_f32 v105, v105, v20
  v_sub_f32 v106, v106, v20
  v_sub_f32 v107, v107, v20
  v_sub_f32 v108, v108, v20
  v_sub_f32 v109, v109, v20
  v_sub_f32 v110, v110, v20
  v_sub_f32 v111, v111, v20
  v_exp_f32 v96, v96
  v_exp_f32 v97, v97
  v_add_f32 v64, v64, v96
  v_exp_f32 v98, v98
  v_add_f32 v64, v64, v97
  v_cvt_pk_bf16_f32 v80, v96, v97
  v_exp_f32 v99, v99
  v_add_f32 v64, v64, v98
  v_exp_f32 v100, v100
  v_add_f32 v64, v64, v99
  v_cvt_pk_bf16_f32 v81, v98, v99
  v_exp_f32 v101, v101
  v_add_f32 v64, v64, v100
  v_exp_f32 v102, v102
  v_add_f32 v64, v64, v101
  v_cvt_pk_bf16_f32 v82, v100, v101
  v_exp_f32 v103, v103
  v_add_f32 v64, v64, v102
  v_exp_f32 v104, v104
  v_add_f32 v64, v64, v103
  v_cvt_pk_bf16_f32 v83, v102, v103
  v_exp_f32 v105, v105
  v_add_f32 v64, v64, v104
  v_exp_f32 v106, v106
  v_add_f32 v64, v64, v105
  v_cvt_pk_bf16_f32 v84, v104, v105
  v_exp_f32 v107, v107
  v_add_f32 v64, v64, v106
  v_exp_f32 v108, v108
  v_add_f32 v64, v64, v107
  v_cvt_pk_bf16_f32 v85, v106, v107
  v_exp_f32 v109, v109
  v_add_f32 v64, v64, v108
  v_exp_f32 v110, v110
  v_add_f32 v64, v64, v109
  v_cvt_pk_bf16_f32 v86, v108, v109
  v_exp_f32 v111, v111
  v_add_f32 v64, v64, v110
  v_add_f32 v64, v64, v111
  v_cvt_pk_bf16_f32 v87, v110, v111
  ds_read_b64_tr_b16 a[128:129], v48 offset:0
  ds_read_b64_tr_b16 a[130:131], v48 offset:2048
  ds_read_b64_tr_b16 a[132:133], v49 offset:0
  ds_read_b64_tr_b16 a[134:135], v49 offset:2048
  ds_read_b64_tr_b16 a[136:137], v50 offset:0
  ds_read_b64_tr_b16 a[138:139], v50 offset:2048
  ds_read_b64_tr_b16 a[140:141], v51 offset:0
  ds_read_b64_tr_b16 a[142:143], v51 offset:2048
  ds_read_b64_tr_b16 a[144:145], v48 offset:4096
  ds_read_b64_tr_b16 a[146:147], v48 offset:6144
  ds_read_b64_tr_b16 a[148:149], v49 offset:4096
  ds_read_b64_tr_b16 a[150:151], v49 offset:6144
  ds_read_b64_tr_b16 a[152:153], v50 offset:4096
  ds_read_b64_tr_b16 a[154:155], v50 offset:6144
  ds_read_b64_tr_b16 a[156:157], v51 offset:4096
  ds_read_b64_tr_b16 a[158:159], v51 offset:6144
  s_waitcnt lgkmcnt(0)
  v_mfma_f32_32x32x16_bf16 v[128:143], a[128:131], v[80:83], v[128:143]
  v_mfma_f32_32x32x16_bf16 v[144:159], a[132:135], v[80:83], v[144:159]
  v_mfma_f32_32x32x16_bf16 v[160:175], a[136:139], v[80:83], v[160:175]
  v_mfma_f32_32x32x16_bf16 v[176:191], a[140:143], v[80:83], v[176:191]
  v_mfma_f32_32x32x16_bf16 v[128:143], a[144:147], v[84:87], v[128:143]
  v_mfma_f32_32x32x16_bf16 v[144:159], a[148:151], v[84:87], v[144:159]
  v_mfma_f32_32x32x16_bf16 v[160:175], a[152:155], v[84:87], v[160:175]
  v_mfma_f32_32x32x16_bf16 v[176:191], a[156:159], v[84:87], v[176:191]
  ds_read_b128 a[80:83], v40 offset:8192
  ds_read_b128 a[84:87], v41 offset:8192
  ds_read_b128 a[88:91], v42 offset:8192
  ds_read_b128 a[92:95], v43 offset:8192
  ds_read_b128 a[96:99], v44 offset:8192
  ds_read_b128 a[100:103], v45 offset:8192
  ds_read_b128 a[104:107], v46 offset:8192
  ds_read_b128 a[108:111], v47 offset:8192
  s_waitcnt lgkmcnt(0)
  v_mfma_f32_32x32x16_bf16 v[96:111], a[80:83], v[192:195], 0
  v_mfma_f32_32x32x16_bf16 v[96:111], a[84:87], v[196:199], v[96:111]
  v_mfma_f32_32x32x16_bf16 v[96:111], a[88:91], v[200:203], v[96:111]
  v_mfma_f32_32x32x16_bf16 v[96:111], a[92:95], v[204:207], v[96:111]
  v_mfma_f32_32x32x16_bf16 v[96:111], a[96:99], v[208:211], v[96:111]
  v_mfma_f32_32x32x16_bf16 v[96:111], a[100:103], v[212:215], v[96:111]
  v_mfma_f32_32x32x16_bf16 v[96:111], a[104:107], v[216:219], v[96:111]
  v_mfma_f32_32x32x16_bf16 v[96:111], a[108:111], v[220:223], v[96:111]
  s_nop 15
  s_nop 7
  v_sub_f32 v96, v96, v20
  v_sub_f32 v97, v97, v20
  v_sub_f32 v98, v98, v20
  v_sub_f32 v99, v99, v20
  v_sub_f32 v100, v100, v20
  v_sub_f32 v101, v101, v20
  v_sub_f32 v102, v102, v20
  v_sub_f32 v103, v103, v20
  v_sub_f32 v104, v104, v20
  v_sub_f32 v105, v105, v20
  v_sub_f32 v106, v106, v20
  v_sub_f32 v107, v107, v20
  v_sub_f32 v108, v108, v20
  v_sub_f32 v109, v109, v20
  v_sub_f32 v110, v110, v20
  v_sub_f32 v111, v111, v20
  v_exp_f32 v96, v96
  v_exp_f32 v97, v97
  v_add_f32 v64, v64, v96
  v_exp_f32 v98, v98
  v_add_f32 v64, v64, v97
  v_cvt_pk_bf16_f32 v80, v96, v97
  v_exp_f32 v99, v99
  v_add_f32 v64, v64, v98
  v_exp_f32 v100, v100
  v_add_f32 v64, v64, v99
  v_cvt_pk_bf16_f32 v81, v98, v99
  v_exp_f32 v101, v101
  v_add_f32 v64, v64, v100
  v_exp_f32 v102, v102
  v_add_f32 v64, v64, v101
  v_cvt_pk_bf16_f32 v82, v100, v101
  v_exp_f32 v103, v103
  v_add_f32 v64, v64, v102
  v_exp_f32 v104, v104
  v_add_f32 v64, v64, v103
  v_cvt_pk_bf16_f32 v83, v102, v103
  v_exp_f32 v105, v105
  v_add_f32 v64, v64, v104
  v_exp_f32 v106, v106
  v_add_f32 v64, v64, v105
  v_cvt_pk_bf16_f32 v84, v104, v105
  v_exp_f32 v107, v107
  v_add_f32 v64, v64, v106
  v_exp_f32 v108, v108
  v_add_f32 v64, v64, v107
  v_cvt_pk_bf16_f32 v85, v106, v107
  v_exp_f32 v109, v109
  v_add_f32 v64, v64, v108
  v_exp_f32 v110, v110
  v_add_f32 v64, v64, v109
  v_cvt_pk_bf16_f32 v86, v108, v109
  v_exp_f32 v111, v111
  v_add_f32 v64, v64, v110
  v_add_f32 v64, v64, v111
  v_cvt_pk_bf16_f32 v87, v110, v111
  ds_read_b64_tr_b16 a[128:129], v48 offset:8192
  ds_read_b64_tr_b16 a[130:131], v48 offset:10240
  ds_read_b64_tr_b16 a[132:133], v49 offset:8192
  ds_read_b64_tr_b16 a[134:135], v49 offset:10240
  ds_read_b64_tr_b16 a[136:137], v50 offset:8192
  ds_read_b64_tr_b16 a[138:139], v50 offset:10240
  ds_read_b64_tr_b16 a[140:141], v51 offset:8192
  ds_read_b64_tr_b16 a[142:143], v51 offset:10240
  ds_read_b64_tr_b16 a[144:145], v48 offset:12288
  ds_read_b64_tr_b16 a[146:147], v48 offset:14336
  ds_read_b64_tr_b16 a[148:149], v49 offset:12288
  ds_read_b64_tr_b16 a[150:151], v49 offset:14336
  ds_read_b64_tr_b16 a[152:153], v50 offset:12288
  ds_read_b64_tr_b16 a[154:155], v50 offset:14336
  ds_read_b64_tr_b16 a[156:157], v51 offset:12288
  ds_read_b64_tr_b16 a[158:159], v51 offset:14336
  s_waitcnt lgkmcnt(0)
  v_mfma_f32_32x32x16_bf16 v[128:143], a[128:131], v[80:83], v[128:143]
  v_mfma_f32_32x32x16_bf16 v[144:159], a[132:135], v[80:83], v[144:159]
  v_mfma_f32_32x32x16_bf16 v[160:175], a[136:139], v[80:83], v[160:175]
  v_mfma_f32_32x32x16_bf16 v[176:191], a[140:143], v[80:83], v[176:191]
  v_mfma_f32_32x32x16_bf16 v[128:143], a[144:147], v[84:87], v[128:143]
  v_mfma_f32_32x32x16_bf16 v[144:159], a[148:151], v[84:87], v[144:159]
  v_mfma_f32_32x32x16_bf16 v[160:175], a[152:155], v[84:87], v[160:175]
  v_mfma_f32_32x32x16_bf16 v[176:191], a[156:159], v[84:87], v[176:191]
  ds_read_b128 a[112:115], v52 offset:0
  ds_read_b128 a[116:119], v53 offset:0
  ds_read_b128 a[120:123], v54 offset:0
  ds_read_b128 a[124:127], v55 offset:0
  s_waitcnt lgkmcnt(0)
  v_mfma_f32_16x16x32_bf16 v[72:75], a[112:115], a[64:67], 0
  v_mfma_f32_16x16x32_bf16 v[72:75], a[116:119], a[68:71], v[72:75]
  v_mfma_f32_16x16x32_bf16 v[72:75], a[120:123], a[72:75], v[72:75]
  v_mfma_f32_16x16x32_bf16 v[72:75], a[124:127], a[76:79], v[72:75]
  s_nop 15
  v_sub_f32 v72, v72, v21
  v_sub_f32 v73, v73, v21
  v_sub_f32 v74, v74, v21
  v_sub_f32 v75, v75, v21
  v_exp_f32 v72, v72
  v_exp_f32 v73, v73
  v_add_f32 v66, v66, v72
  v_exp_f32 v74, v74
  v_add_f32 v66, v66, v73
  v_cvt_pk_bf16_f32 v70, v72, v73
  v_exp_f32 v75, v75
  v_add_f32 v66, v66, v74
  v_add_f32 v66, v66, v75
  v_cvt_pk_bf16_f32 v71, v74, v75
  ds_read_b64_tr_b16 a[160:161], v56 offset:0
  ds_read_b64_tr_b16 a[162:163], v57 offset:0
  ds_read_b64_tr_b16 a[164:165], v58 offset:0
  ds_read_b64_tr_b16 a[166:167], v59 offset:0
  ds_read_b64_tr_b16 a[168:169], v60 offset:0
  ds_read_b64_tr_b16 a[170:171], v61 offset:0
  ds_read_b64_tr_b16 a[172:173], v62 offset:0
  ds_read_b64_tr_b16 a[174:175], v63 offset:0
  s_waitcnt lgkmcnt(0)
  v_mfma_f32_16x16x16_bf16 a[176:179], a[160:161], v[70:71], a[176:179]
  v_mfma_f32_16x16x16_bf16 a[180:183], a[162:163], v[70:71], a[180:183]
  v_mfma_f32_16x16x16_bf16 a[184:187], a[164:165], v[70:71], a[184:187]
  v_mfma_f32_16x16x16_bf16 a[188:191], a[166:167], v[70:71], a[188:191]
  v_mfma_f32_16x16x16_bf16 a[192:195], a[168:169], v[70:71], a[192:195]
  v_mfma_f32_16x16x16_bf16 a[196:199], a[170:171], v[70:71], a[196:199]
  v_mfma_f32_16x16x16_bf16 a[200:203], a[172:173], v[70:71], a[200:203]
  v_mfma_f32_16x16x16_bf16 a[204:207], a[174:175], v[70:71], a[204:207]
  s_barrier
  s_add_u32 s50, s50, 16384
  s_add_u32 s34, s34, 1
  s_cmp_lt_u32 s34, 8
  s_cbranch_scc1 K1_SLOW_L2
  s_nop 15
  s_nop 7
  s_branch K1_EPI
K1_END:
  s_endpgm
K1_CODE_END:
.section .rodata,"a"
.p2align 6
.amdhsa_kernel standalone__mha_block_cached__near_ridge_kernel
  .amdhsa_next_free_vgpr 512
  .amdhsa_next_free_sgpr 102
  .amdhsa_accum_offset 256
  .amdhsa_group_segment_fixed_size 0
  .amdhsa_kernarg_size 64
  .amdhsa_user_sgpr_count 2
  .amdhsa_user_sgpr_kernarg_segment_ptr 1
  .amdhsa_system_sgpr_workgroup_id_x 1
  .amdhsa_float_denorm_mode_32 3
.end_amdhsa_kernel
```
